```python
import torch

def _softmax(x, axis=-1):
    return torch.softmax(x, dim=axis)
def _gelu(x):
    return torch.nn.functional.gelu(x, approximate="tanh")
def _silu(x):
    return torch.nn.functional.silu(x)
def _sigmoid(x):
    return torch.sigmoid(x)
def _layernorm(x, axis=-1, eps=1e-5):
    m = x.mean(dim=axis, keepdim=True)
    v = x.var(dim=axis, keepdim=True, unbiased=False)
    return (x - m) / torch.sqrt(v + eps)
def _scatter_add(tgt, idx, src, axis=0):
    return tgt.clone().index_add_(axis, idx, src)
def _segment_sum(src, seg, n):
    out = torch.zeros((n,) + src.shape[1:], dtype=src.dtype)
    return out.index_add_(0, seg, src)
def _pad(x, pw):
    flat = tuple(v for pair in reversed(pw) for v in pair)
    return torch.nn.functional.pad(x, flat)

kernel_name = 'recurrent_scan__compressed_kv_cla__geglu_ffn__decode'

def setup_inputs():

    _w = (lambda a: (lambda t: t.to(torch.bfloat16) if t.is_floating_point() else t)(torch.as_tensor(a)))
    def _A_setup():
        B, H, Sq, Sk, D, M = 2, 16, 1, 4096, 256, 448
        Dc = 4 * D
        return {
            "x": _w((lambda *s: torch.randn(*s, dtype=torch.bfloat16) * 0.05)(B, Sq, M)),
            "c_kv": _w((lambda *s: torch.randn(*s, dtype=torch.bfloat16) * 0.8)(B, Sk, Dc)),
            "w_q": _w((lambda *s: torch.randn(*s, dtype=torch.bfloat16) * 1.6)(M, H, D) * (M ** -0.5)),
            "w_uk": _w((lambda *s: torch.randn(*s, dtype=torch.bfloat16) * 1.6)(Dc, H, D) * (Dc ** -0.5)),
            "w_uv": _w((lambda *s: torch.randn(*s, dtype=torch.bfloat16) * 0.8)(Dc, H, D) * (Dc ** -0.5)),
            "w_o": _w((lambda *s: torch.randn(*s, dtype=torch.bfloat16) * 0.8)(H, D, M) * ((H * D) ** -0.5)),
        }
    _A_in = _A_setup()

    def _B_setup():
        B, S, D, F = 2, 1, 448, 1792
        return {
            "x": _w((lambda *s: torch.randn(*s, dtype=torch.bfloat16) * 0.05)(B, S, D)),
            "w_gate": _w((lambda *s: torch.randn(*s, dtype=torch.bfloat16) * 0.2)(D, F)),
            "w_up": _w((lambda *s: torch.randn(*s, dtype=torch.bfloat16) * 0.2)(D, F)),
            "w_down": _w((lambda *s: torch.randn(*s, dtype=torch.bfloat16) * 0.2)(F, D)),
        }
    _B_in = _B_setup()

    return {
        "A_x": _A_in["x"],
        "A_c_kv": _A_in["c_kv"],
        "A_w_q": _A_in["w_q"],
        "A_w_uk": _A_in["w_uk"],
        "A_w_uv": _A_in["w_uv"],
        "A_w_o": _A_in["w_o"],
        "B_x": _B_in["x"],
        "B_w_gate": _B_in["w_gate"],
        "B_w_up": _B_in["w_up"],
        "B_w_down": _B_in["w_down"],
    }

def reference(A_x, A_c_kv, A_w_q, A_w_uk, A_w_uv, A_w_o, B_x, B_w_gate, B_w_up, B_w_down):
    def _A_ref(x, c_kv, w_q, w_uk, w_uv, w_o):
        B, Sq, M = x.shape[0], x.shape[1], x.shape[2]
        Sk = c_kv.shape[1]
        H, D = w_q.shape[1], w_q.shape[2]
        q = torch.einsum("bqm,mhd->bhqd", x, w_q)
        k = torch.einsum("bkc,chd->bhkd", c_kv, w_uk)
        v = torch.einsum("bkc,chd->bhkd", c_kv, w_uv)
        scores = torch.einsum("bhqd,bhkd->bhqk", q, k) * (D ** -0.5)
        off = Sk - Sq
        qi = torch.arange(Sq)[:, None]
        kj = torch.arange(Sk)[None, :]
        cmask = kj <= (qi + off)
        scores = torch.where(cmask[None, None], scores, -1e9)
        p = _softmax(scores, axis=-1)
        ctx = torch.einsum("bhqk,bhkd->bhqd", p, v)
        return torch.einsum("bhqd,hdm->bqm", ctx, w_o)

    def _B_ref(x, w_gate, w_up, w_down):
        return (_gelu(x @ w_gate) * (x @ w_up)) @ w_down

    x = A_x
    xn = _layernorm(x, axis=-1)
    s = _A_ref(xn, A_c_kv, A_w_q, A_w_uk, A_w_uv, A_w_o)
    g = _silu(_B_ref(xn, B_w_gate, B_w_up, B_w_down))
    return x + s * g
```

```asm
; @launch grid=(256,1,1) block=(256,1,1) lds=163840
.amdgcn_target "amdgcn-amd-amdhsa--gfx950"
.text
.globl recurrent_scan__compressed_kv_cla__geglu_ffn__decode_kernel
.p2align 8
.type recurrent_scan__compressed_kv_cla__geglu_ffn__decode_kernel,@function
recurrent_scan__compressed_kv_cla__geglu_ffn__decode_kernel:
  s_cmp_ge_u32 s2, 256
  s_cbranch_scc1 L_end0
  s_load_dwordx16 s[4:19], s[0:1], 0
  s_load_dwordx8 s[20:27], s[0:1], 64
  s_load_dwordx2 s[28:29], s[0:1], 96
  v_lshrrev_b32 v4, 6, v0
  v_and_b32 v0, 63, v0
  v_readfirstlane_b32 s3, v4
  v_and_b32 v1, 15, v0
  v_lshrrev_b32 v2, 4, v0
  v_and_b32 v14, 1, v0
  s_and_b32 s31, s2, 127
  v_lshrrev_b32 v12, 5, v0
  v_and_b32 v11, 31, v0
  s_mov_b32 s34, 16777216
  s_mov_b32 s35, 0x20000
  s_mov_b32 s43, 0x20000
  v_lshrrev_b32 v7, 3, v0
  v_and_b32 v6, 6, v7
  v_and_b32 v8, 7, v0
  v_xor_b32 v6, v6, v8
  v_lshlrev_b32 v6, 4, v6
  v_mul_u32_u24 v10, 28, v0
  s_cmp_ge_u32 s2, 128
  s_cbranch_scc1 L_A
  s_and_b32 s60, s31, 15
  s_lshr_b32 s61, s31, 4
  s_lshl_b32 s59, s3, 14
  s_add_u32 s59, s59, 32768
  s_getpc_b64 s[50:51]
L_pc1:
  s_sub_u32 s50, s50, L_pc1-recurrent_scan__compressed_kv_cla__geglu_ffn__decode_kernel
  s_subb_u32 s51, s51, 0
  s_lshr_b32 s52, s31, 3
  s_mul_i32 s52, s52, 4
  s_add_u32 s52, s52, s3
  s_min_u32 s52, s52, 21
  s_lshl_b32 s52, s52, 10
  v_lshlrev_b32 v5, 4, v0
  v_add_u32 v4, s52, v5
  global_load_dwordx4 v[250:253], v4, s[50:51]
  v_lshl_add_u32 v9, v7, 13, v6
  s_and_b32 s53, s2, 1
  s_lshr_b32 s54, s2, 1
  s_mul_i32 s55, s53, 1835008
  s_lshl_b32 s56, s54, 7
  s_add_u32 s55, s55, s56
  s_lshl_b32 s56, s3, 16
  s_add_u32 s55, s55, s56
  s_lshl_b32 s57, s3, 10
  s_add_u32 s57, s57, 4096
  s_mov_b32 s38, 3670016
  s_mov_b32 s39, 0x20000
  s_lshl_b32 s58, s61, 7
  s_lshl_b32 s62, s60, 9
  s_lshl_b32 s58, s58, 13
  s_add_u32 s58, s58, s62
  s_and_b32 s62, s3, 1
  s_lshl_b32 s62, s62, 16
  s_lshr_b32 s63, s3, 1
  s_lshl_b32 s63, s63, 19
  s_add_u32 s62, s62, s63
  s_add_u32 s56, s58, s62
  v_xor_b32 v11, v11, v12
  v_lshlrev_b32 v11, 4, v11
  v_lshl_add_u32 v11, v12, 14, v11
  s_mov_b32 s42, 8388608
  s_waitcnt lgkmcnt(0)
  s_cmp_eq_u32 s3, 3
  s_cbranch_scc0 L_nx
  global_load_dwordx4 v[16:19], v10, s[4:5]
  global_load_dwordx3 v[20:22], v10, s[4:5] offset:16
L_nx:
  s_mov_b32 s36, s8
  s_mov_b32 s37, s9
  s_add_u32 m0, s57, 0
  s_nop 0
  buffer_load_dwordx4 v9, s[36:39], s55 offen nt lds
  s_add_u32 s55, s55, 262144
  s_add_u32 m0, s57, 4096
  s_nop 0
  buffer_load_dwordx4 v9, s[36:39], s55 offen nt lds
  s_add_u32 s55, s55, 262144
  s_add_u32 m0, s57, 8192
  s_nop 0
  buffer_load_dwordx4 v9, s[36:39], s55 offen nt lds
  s_add_u32 s55, s55, 262144
  s_add_u32 m0, s57, 12288
  s_nop 0
  buffer_load_dwordx4 v9, s[36:39], s55 offen nt lds
  s_add_u32 s55, s55, 262144
  s_add_u32 m0, s57, 16384
  s_nop 0
  buffer_load_dwordx4 v9, s[36:39], s55 offen nt lds
  s_add_u32 s55, s55, 262144
  s_add_u32 m0, s57, 20480
  s_nop 0
  buffer_load_dwordx4 v9, s[36:39], s55 offen nt lds
  s_add_u32 s55, s55, 262144
  s_add_u32 m0, s57, 24576
  s_nop 0
  buffer_load_dwordx4 v9, s[36:39], s55 offen nt lds
  s_load_dword s30, s[28:29], 0
  s_mov_b32 s32, s28
  s_mov_b32 s33, s29
  s_mov_b32 s40, s10
  s_mov_b32 s41, s11
  s_mov_b32 s44, 0x07060500
  s_mov_b32 s45, 0x07060501
  s_mov_b32 s46, 0x07060502
  s_mov_b32 s47, 0x07060503
  s_mov_b32 s48, 0x0c0c0400
  s_mov_b32 s49, 0x04000c0c
  s_cmp_eq_u32 s3, 3
  s_cbranch_scc0 L_nln
  s_waitcnt vmcnt(7)
  v_lshlrev_b32 v24, 16, v16
  v_and_b32 v25, 0xffff0000, v16
  v_lshlrev_b32 v26, 16, v17
  v_and_b32 v27, 0xffff0000, v17
  v_lshlrev_b32 v28, 16, v18
  v_and_b32 v29, 0xffff0000, v18
  v_lshlrev_b32 v30, 16, v19
  v_and_b32 v31, 0xffff0000, v19
  v_lshlrev_b32 v32, 16, v20
  v_and_b32 v33, 0xffff0000, v20
  v_lshlrev_b32 v34, 16, v21
  v_and_b32 v35, 0xffff0000, v21
  v_lshlrev_b32 v36, 16, v22
  v_and_b32 v37, 0xffff0000, v22
  v_add_f32 v40, v24, v25
  v_add_f32 v41, v26, v27
  v_add_f32 v40, v40, v28
  v_add_f32 v41, v41, v29
  v_add_f32 v40, v40, v30
  v_add_f32 v41, v41, v31
  v_add_f32 v40, v40, v32
  v_add_f32 v41, v41, v33
  v_add_f32 v40, v40, v34
  v_add_f32 v41, v41, v35
  v_add_f32 v40, v40, v36
  v_add_f32 v41, v41, v37
  v_add_f32 v40, v40, v41
  s_nop 1
  v_add_f32_dpp v40, v40, v40 row_ror:8 row_mask:0xf bank_mask:0xf
  s_nop 1
  v_add_f32_dpp v40, v40, v40 row_ror:4 row_mask:0xf bank_mask:0xf
  s_nop 1
  v_add_f32_dpp v40, v40, v40 row_ror:2 row_mask:0xf bank_mask:0xf
  s_nop 1
  v_add_f32_dpp v40, v40, v40 row_ror:1 row_mask:0xf bank_mask:0xf
  v_mov_b32 v41, v40
  s_nop 1
  v_permlane16_swap_b32 v41, v40
  v_add_f32 v40, v40, v41
  v_mul_f32 v40, 0x3b124925, v40
  v_sub_f32 v42, v24, v40
  v_sub_f32 v43, v25, v40
  v_mul_f32 v44, v42, v42
  v_mul_f32 v45, v43, v43
  v_sub_f32 v42, v26, v40
  v_sub_f32 v43, v27, v40
  v_fmac_f32 v44, v42, v42
  v_fmac_f32 v45, v43, v43
  v_sub_f32 v42, v28, v40
  v_sub_f32 v43, v29, v40
  v_fmac_f32 v44, v42, v42
  v_fmac_f32 v45, v43, v43
  v_sub_f32 v42, v30, v40
  v_sub_f32 v43, v31, v40
  v_fmac_f32 v44, v42, v42
  v_fmac_f32 v45, v43, v43
  v_sub_f32 v42, v32, v40
  v_sub_f32 v43, v33, v40
  v_fmac_f32 v44, v42, v42
  v_fmac_f32 v45, v43, v43
  v_sub_f32 v42, v34, v40
  v_sub_f32 v43, v35, v40
  v_fmac_f32 v44, v42, v42
  v_fmac_f32 v45, v43, v43
  v_sub_f32 v42, v36, v40
  v_sub_f32 v43, v37, v40
  v_fmac_f32 v44, v42, v42
  v_fmac_f32 v45, v43, v43
  v_add_f32 v44, v44, v45
  s_nop 1
  v_add_f32_dpp v44, v44, v44 row_ror:8 row_mask:0xf bank_mask:0xf
  s_nop 1
  v_add_f32_dpp v44, v44, v44 row_ror:4 row_mask:0xf bank_mask:0xf
  s_nop 1
  v_add_f32_dpp v44, v44, v44 row_ror:2 row_mask:0xf bank_mask:0xf
  s_nop 1
  v_add_f32_dpp v44, v44, v44 row_ror:1 row_mask:0xf bank_mask:0xf
  v_mov_b32 v45, v44
  s_nop 1
  v_permlane16_swap_b32 v45, v44
  v_add_f32 v44, v44, v45
  v_mul_f32 v44, 0x3b124925, v44
  v_cvt_pk_bf16_f32 v40, v40, v40
  v_and_b32 v40, 0xffff0000, v40
  v_cvt_pk_bf16_f32 v44, v44, v44
  v_and_b32 v44, 0xffff0000, v44
  v_add_f32 v44, 0x3727c5ac, v44
  v_cvt_pk_bf16_f32 v44, v44, v44
  v_and_b32 v44, 0xffff0000, v44
  v_sqrt_f32 v44, v44
  s_nop 0
  v_cvt_pk_bf16_f32 v44, v44, v44
  v_and_b32 v44, 0xffff0000, v44
  v_rcp_f32 v44, v44
  v_sub_f32 v42, v24, v40
  v_sub_f32 v43, v25, v40
  v_cvt_pk_bf16_f32 v42, v42, v43
  v_and_b32 v43, 0xffff0000, v42
  v_lshlrev_b32 v42, 16, v42
  v_mul_f32 v42, v42, v44
  v_mul_f32 v43, v43, v44
  v_cvt_pk_bf16_f32 v16, v42, v43
  v_sub_f32 v42, v26, v40
  v_sub_f32 v43, v27, v40
  v_cvt_pk_bf16_f32 v42, v42, v43
  v_and_b32 v43, 0xffff0000, v42
  v_lshlrev_b32 v42, 16, v42
  v_mul_f32 v42, v42, v44
  v_mul_f32 v43, v43, v44
  v_cvt_pk_bf16_f32 v17, v42, v43
  v_sub_f32 v42, v28, v40
  v_sub_f32 v43, v29, v40
  v_cvt_pk_bf16_f32 v42, v42, v43
  v_and_b32 v43, 0xffff0000, v42
  v_lshlrev_b32 v42, 16, v42
  v_mul_f32 v42, v42, v44
  v_mul_f32 v43, v43, v44
  v_cvt_pk_bf16_f32 v18, v42, v43
  v_sub_f32 v42, v30, v40
  v_sub_f32 v43, v31, v40
  v_cvt_pk_bf16_f32 v42, v42, v43
  v_and_b32 v43, 0xffff0000, v42
  v_lshlrev_b32 v42, 16, v42
  v_mul_f32 v42, v42, v44
  v_mul_f32 v43, v43, v44
  v_cvt_pk_bf16_f32 v19, v42, v43
  v_sub_f32 v42, v32, v40
  v_sub_f32 v43, v33, v40
  v_cvt_pk_bf16_f32 v42, v42, v43
  v_and_b32 v43, 0xffff0000, v42
  v_lshlrev_b32 v42, 16, v42
  v_mul_f32 v42, v42, v44
  v_mul_f32 v43, v43, v44
  v_cvt_pk_bf16_f32 v20, v42, v43
  v_sub_f32 v42, v34, v40
  v_sub_f32 v43, v35, v40
  v_cvt_pk_bf16_f32 v42, v42, v43
  v_and_b32 v43, 0xffff0000, v42
  v_lshlrev_b32 v42, 16, v42
  v_mul_f32 v42, v42, v44
  v_mul_f32 v43, v43, v44
  v_cvt_pk_bf16_f32 v21, v42, v43
  v_sub_f32 v42, v36, v40
  v_sub_f32 v43, v37, v40
  v_cvt_pk_bf16_f32 v42, v42, v43
  v_and_b32 v43, 0xffff0000, v42
  v_lshlrev_b32 v42, 16, v42
  v_mul_f32 v42, v42, v44
  v_mul_f32 v43, v43, v44
  v_cvt_pk_bf16_f32 v22, v42, v43
  ds_write2_b32 v10, v16, v17 offset0:0 offset1:1
  ds_write2_b32 v10, v18, v19 offset0:2 offset1:3
  ds_write2_b32 v10, v20, v21 offset0:4 offset1:5
  ds_write_b32 v10, v22 offset:24
L_nln:
  v_xor_b32 v13, 0, v11
  s_add_u32 s62, s56, 0
  s_add_u32 m0, s59, 0
  s_nop 0
  buffer_load_dwordx4 v13, s[40:43], s62 offen nt lds
  v_xor_b32 v13, 32, v11
  s_add_u32 s62, s56, 32768
  s_add_u32 m0, s59, 1024
  s_nop 0
  buffer_load_dwordx4 v13, s[40:43], s62 offen nt lds
  v_xor_b32 v13, 64, v11
  s_add_u32 s62, s56, 131072
  s_add_u32 m0, s59, 2048
  s_nop 0
  buffer_load_dwordx4 v13, s[40:43], s62 offen nt lds
  v_xor_b32 v13, 96, v11
  s_add_u32 s62, s56, 163840
  s_add_u32 m0, s59, 3072
  s_nop 0
  buffer_load_dwordx4 v13, s[40:43], s62 offen nt lds
  v_xor_b32 v13, 128, v11
  s_add_u32 s62, s56, 262144
  s_add_u32 m0, s59, 4096
  s_nop 0
  buffer_load_dwordx4 v13, s[40:43], s62 offen nt lds
  v_xor_b32 v13, 160, v11
  s_add_u32 s62, s56, 294912
  s_add_u32 m0, s59, 5120
  s_nop 0
  buffer_load_dwordx4 v13, s[40:43], s62 offen nt lds
  v_xor_b32 v13, 192, v11
  s_add_u32 s62, s56, 393216
  s_add_u32 m0, s59, 6144
  s_nop 0
  buffer_load_dwordx4 v13, s[40:43], s62 offen nt lds
  s_waitcnt lgkmcnt(0)
  s_add_u32 s30, s30, 0x01010101
  v_mov_b32 v3, s30
  v_xor_b32 v13, 224, v11
  s_add_u32 s62, s56, 425984
  s_add_u32 m0, s59, 7168
  s_nop 0
  buffer_load_dwordx4 v13, s[40:43], s62 offen nt lds
  v_lshrrev_b32 v39, 2, v1
  v_lshl_add_u32 v39, v2, 2, v39
  v_and_b32 v40, 6, v39
  v_bfe_u32 v41, v0, 1, 1
  v_xor_b32 v40, v40, v41
  v_lshlrev_b32 v44, 7, v39
  v_lshl_add_u32 v44, v40, 4, v44
  v_lshl_add_u32 v44, v14, 3, v44
  v_add_u32 v44, 4096, v44
  s_lshl_b32 s62, s3, 5
  v_xor_b32 v44, s62, v44
  v_bfe_u32 v45, v0, 2, 1
  v_and_b32 v46, 3, v0
  v_or_b32 v46, 0x07060500, v46
  s_mul_i32 s63, s31, 16640
  s_lshl_b32 s62, s3, 6
  s_add_u32 s63, s63, s62
  s_add_u32 s63, s63, 2100224
  v_lshlrev_b32 v40, 8, v2
  v_lshl_add_u32 v40, v1, 2, v40
  s_waitcnt vmcnt(8)
  s_barrier
  v_mul_u32_u24 v15, 896, v45
  v_lshl_add_u32 v15, v2, 3, v15
  s_and_b32 s62, s2, 1
  s_mul_i32 s62, s62, 448
  v_add_u32 v15, s62, v15
  ds_read_b64 v[96:97], v15 offset:0
  ds_read_b64 v[98:99], v15 offset:32
  ds_read_b64 v[100:101], v15 offset:64
  ds_read_b64 v[102:103], v15 offset:96
  ds_read_b64 v[104:105], v15 offset:128
  ds_read_b64 v[106:107], v15 offset:160
  ds_read_b64 v[108:109], v15 offset:192
  ds_read_b64 v[110:111], v15 offset:224
  ds_read_b64 v[112:113], v15 offset:256
  ds_read_b64 v[114:115], v15 offset:288
  ds_read_b64 v[116:117], v15 offset:320
  ds_read_b64 v[118:119], v15 offset:352
  ds_read_b64 v[120:121], v15 offset:384
  ds_read_b64 v[122:123], v15 offset:416
  ds_read_b64_tr_b16 v[64:65], v44 offset:0
  ds_read_b64_tr_b16 v[66:67], v44 offset:2048
  ds_read_b64_tr_b16 v[68:69], v44 offset:4096
  ds_read_b64_tr_b16 v[70:71], v44 offset:6144
  ds_read_b64_tr_b16 v[72:73], v44 offset:8192
  ds_read_b64_tr_b16 v[74:75], v44 offset:10240
  ds_read_b64_tr_b16 v[76:77], v44 offset:12288
  ds_read_b64_tr_b16 v[78:79], v44 offset:14336
  ds_read_b64_tr_b16 v[80:81], v44 offset:16384
  ds_read_b64_tr_b16 v[82:83], v44 offset:18432
  ds_read_b64_tr_b16 v[84:85], v44 offset:20480
  ds_read_b64_tr_b16 v[86:87], v44 offset:22528
  ds_read_b64_tr_b16 v[88:89], v44 offset:24576
  ds_read_b64_tr_b16 v[90:91], v44 offset:26624
  s_waitcnt lgkmcnt(12)
  v_mfma_f32_16x16x32_bf16 v[128:131], v[96:99], v[64:67], 0
  s_waitcnt lgkmcnt(10)
  v_mfma_f32_16x16x32_bf16 v[128:131], v[100:103], v[68:71], v[128:131]
  s_waitcnt lgkmcnt(8)
  v_mfma_f32_16x16x32_bf16 v[128:131], v[104:107], v[72:75], v[128:131]
  s_waitcnt lgkmcnt(6)
  v_mfma_f32_16x16x32_bf16 v[128:131], v[108:111], v[76:79], v[128:131]
  s_waitcnt lgkmcnt(4)
  v_mfma_f32_16x16x32_bf16 v[128:131], v[112:115], v[80:83], v[128:131]
  s_waitcnt lgkmcnt(2)
  v_mfma_f32_16x16x32_bf16 v[128:131], v[116:119], v[84:87], v[128:131]
  s_waitcnt lgkmcnt(0)
  v_mfma_f32_16x16x32_bf16 v[128:131], v[120:123], v[88:91], v[128:131]
  s_nop 7
  v_perm_b32 v48, v128, v3, v46
  s_mov_b32 exec_hi, 0
  buffer_store_dword v48, v40, s[32:35], s63 offen sc1
  s_mov_b64 exec, -1
  v_xor_b32 v13, 0, v11
  s_add_u32 s62, s56, 8192
  s_add_u32 m0, s59, 8192
  s_nop 0
  buffer_load_dwordx4 v13, s[40:43], s62 offen nt lds
  v_xor_b32 v13, 32, v11
  s_add_u32 s62, s56, 40960
  s_add_u32 m0, s59, 9216
  s_nop 0
  buffer_load_dwordx4 v13, s[40:43], s62 offen nt lds
  v_xor_b32 v13, 64, v11
  s_add_u32 s62, s56, 139264
  s_add_u32 m0, s59, 10240
  s_nop 0
  buffer_load_dwordx4 v13, s[40:43], s62 offen nt lds
  v_xor_b32 v13, 96, v11
  s_add_u32 s62, s56, 172032
  s_add_u32 m0, s59, 11264
  s_nop 0
  buffer_load_dwordx4 v13, s[40:43], s62 offen nt lds
  v_xor_b32 v13, 128, v11
  s_add_u32 s62, s56, 270336
  s_add_u32 m0, s59, 12288
  s_nop 0
  buffer_load_dwordx4 v13, s[40:43], s62 offen nt lds
  v_xor_b32 v13, 160, v11
  s_add_u32 s62, s56, 303104
  s_add_u32 m0, s59, 13312
  s_nop 0
  buffer_load_dwordx4 v13, s[40:43], s62 offen nt lds
  v_xor_b32 v13, 192, v11
  s_add_u32 s62, s56, 401408
  s_add_u32 m0, s59, 14336
  s_nop 0
  buffer_load_dwordx4 v13, s[40:43], s62 offen nt lds
  v_xor_b32 v13, 224, v11
  s_add_u32 s62, s56, 434176
  s_add_u32 m0, s59, 15360
  s_nop 0
  buffer_load_dwordx4 v13, s[40:43], s62 offen nt lds
  v_and_b32 v40, 31, v0
  v_lshlrev_b32 v40, 4, v40
  v_mul_u32_u24 v41, 16640, v12
  v_add_u32 v40, v40, v41
  s_lshl_b32 s63, s60, 2
  s_add_u32 s63, s63, s3
  s_mul_i32 s63, s63, 33280
  s_add_u32 s63, s63, 2100224
  buffer_load_dwordx4 v[44:47], v40, s[32:35], s63 offen sc1
  v_xor_b32 v41, v2, v1
  v_lshlrev_b32 v41, 4, v41
  v_lshl_add_u32 v41, v1, 9, v41
  v_add_u32 v41, s59, v41
  v_xor_b32 v42, 64, v41
  v_xor_b32 v43, 128, v41
  v_xor_b32 v52, 192, v41
  v_and_b32 v56, 1, v2
  v_lshlrev_b32 v56, 9, v56
  v_lshl_add_u32 v56, v1, 3, v56
  v_lshl_add_u32 v56, v12, 2, v56
  s_lshl_b32 s62, s3, 7
  s_add_u32 s62, s62, 1792
  v_add_u32 v56, s62, v56
  v_bfe_u32 v57, v0, 2, 1
  v_lshlrev_b32 v57, 9, v57
  v_lshl_add_u32 v57, v2, 4, v57
  v_lshlrev_b32 v58, 8, v2
  v_lshl_add_u32 v58, v1, 2, v58
  s_mul_i32 s64, s31, 16640
  s_lshl_b32 s62, s3, 6
  s_add_u32 s64, s64, s62
  s_add_u32 s64, s64, 2100736
  v_lshlrev_b32 v59, 1, v1
  v_lshrrev_b32 v59, v59, v3
  v_bfe_u32 v60, v59, 1, 1
  v_and_b32 v59, 1, v59
  v_lshl_or_b32 v59, v60, 16, v59
  v_xor_b32 v60, 0x10001, v59
  s_mov_b32 s65, 0xfffefffe
  s_mov_b32 s67, 0x07060302
  s_waitcnt vmcnt(9)
  ds_read_b128 a[0:3], v41 offset:0
  ds_read_b128 a[4:7], v42 offset:0
  ds_read_b128 a[8:11], v43 offset:0
  ds_read_b128 a[12:15], v52 offset:0
  ds_read_b128 a[16:19], v41 offset:256
  ds_read_b128 a[20:23], v42 offset:256
  ds_read_b128 a[24:27], v43 offset:256
  ds_read_b128 a[28:31], v52 offset:256
  s_waitcnt vmcnt(1)
  ds_read_b128 a[32:35], v41 offset:8192
  ds_read_b128 a[36:39], v42 offset:8192
  ds_read_b128 a[40:43], v43 offset:8192
  ds_read_b128 a[44:47], v52 offset:8192
  ds_read_b128 a[48:51], v41 offset:8448
  ds_read_b128 a[52:55], v42 offset:8448
  ds_read_b128 a[56:59], v43 offset:8448
  ds_read_b128 a[60:63], v52 offset:8448
  s_mov_b32 s96, 400000
L_wq:
  s_waitcnt vmcnt(0)
  v_perm_b32 v53, v45, v44, s48
  v_perm_b32 v54, v47, v46, s49
  v_or_b32 v53, v53, v54
  v_xor_b32 v55, v53, v3
  v_cmp_ne_u32 vcc, 0, v55
  s_cbranch_vccz L_wq_ok
  s_sub_u32 s96, s96, 1
  s_cbranch_scc1 L_end
  buffer_load_dwordx4 v[44:47], v40, s[32:35], s63 offen sc1
  s_branch L_wq
L_wq_ok:
  v_permlane32_swap_b32 v44, v46
  v_permlane32_swap_b32 v45, v47
  v_add_f32 v44, v44, v46
  v_add_f32 v45, v45, v47
  v_cvt_pk_bf16_f32 v44, v44, v45
  ds_write_b32 v56, v44
  s_waitcnt lgkmcnt(0)
  s_barrier
  ds_read_b128 v[64:67], v57 offset:1792
  ds_read_b128 v[68:71], v57 offset:1856
  ds_read_b128 v[72:75], v57 offset:1920
  ds_read_b128 v[76:79], v57 offset:1984
  ds_read_b128 v[80:83], v57 offset:2048
  ds_read_b128 v[84:87], v57 offset:2112
  ds_read_b128 v[88:91], v57 offset:2176
  ds_read_b128 v[92:95], v57 offset:2240
  s_waitcnt lgkmcnt(7)
  v_mfma_f32_16x16x32_bf16 v[96:99], v[64:67], a[0:3], 0
  v_mfma_f32_16x16x32_bf16 v[100:103], v[64:67], a[32:35], 0
  s_waitcnt lgkmcnt(6)
  v_mfma_f32_16x16x32_bf16 v[96:99], v[68:71], a[4:7], v[96:99]
  v_mfma_f32_16x16x32_bf16 v[100:103], v[68:71], a[36:39], v[100:103]
  s_waitcnt lgkmcnt(5)
  v_mfma_f32_16x16x32_bf16 v[96:99], v[72:75], a[8:11], v[96:99]
  v_mfma_f32_16x16x32_bf16 v[100:103], v[72:75], a[40:43], v[100:103]
  s_waitcnt lgkmcnt(4)
  v_mfma_f32_16x16x32_bf16 v[96:99], v[76:79], a[12:15], v[96:99]
  v_mfma_f32_16x16x32_bf16 v[100:103], v[76:79], a[44:47], v[100:103]
  s_waitcnt lgkmcnt(3)
  v_mfma_f32_16x16x32_bf16 v[96:99], v[80:83], a[16:19], v[96:99]
  v_mfma_f32_16x16x32_bf16 v[100:103], v[80:83], a[48:51], v[100:103]
  s_waitcnt lgkmcnt(2)
  v_mfma_f32_16x16x32_bf16 v[96:99], v[84:87], a[20:23], v[96:99]
  v_mfma_f32_16x16x32_bf16 v[100:103], v[84:87], a[52:55], v[100:103]
  s_waitcnt lgkmcnt(1)
  v_mfma_f32_16x16x32_bf16 v[96:99], v[88:91], a[24:27], v[96:99]
  v_mfma_f32_16x16x32_bf16 v[100:103], v[88:91], a[56:59], v[100:103]
  s_waitcnt lgkmcnt(0)
  v_mfma_f32_16x16x32_bf16 v[96:99], v[92:95], a[28:31], v[96:99]
  v_mfma_f32_16x16x32_bf16 v[100:103], v[92:95], a[60:63], v[100:103]
  s_nop 6
  v_mul_f32 v96, 0x3d800000, v96
  v_mul_f32 v100, 0x3d800000, v100
  v_perm_b32 v48, v100, v96, s67
  v_pk_add_u16 v48, v48, v60
  v_and_or_b32 v48, v48, s65, v59
  s_mov_b32 exec_hi, 0
  buffer_store_dword v48, v58, s[32:35], s64 offen sc1
  s_mov_b64 exec, -1
  s_mov_b32 s40, s12
  s_mov_b32 s41, s13
  s_mov_b32 s42, 8388608
  s_mov_b32 s43, 0x20000
  v_and_b32 v8, 7, v0
  v_lshlrev_b32 v8, 4, v8
  v_lshl_add_u32 v11, v7, 13, v8
  s_lshl_b32 s58, s61, 20
  s_lshl_b32 s62, s60, 9
  s_add_u32 s58, s58, s62
  s_lshl_b32 s62, s3, 7
  s_add_u32 s58, s58, s62
  s_add_u32 s59, s59, 65536
  v_xor_b32 v13, 0, v11
  s_add_u32 s62, s58, 0
  s_add_u32 m0, s59, 0
  s_nop 0
  buffer_load_dwordx4 v13, s[40:43], s62 offen nt lds
  s_waitcnt vmcnt(0)
  v_xor_b32 v13, 0, v11
  s_add_u32 s62, s58, 65536
  s_add_u32 m0, s59, 1024
  s_nop 0
  buffer_load_dwordx4 v13, s[40:43], s62 offen nt lds
  s_waitcnt vmcnt(0)
  v_xor_b32 v13, 32, v11
  s_add_u32 s62, s58, 131072
  s_add_u32 m0, s59, 2048
  s_nop 0
  buffer_load_dwordx4 v13, s[40:43], s62 offen nt lds
  v_xor_b32 v13, 32, v11
  s_add_u32 s62, s58, 196608
  s_add_u32 m0, s59, 3072
  s_nop 0
  buffer_load_dwordx4 v13, s[40:43], s62 offen nt lds
  v_xor_b32 v13, 64, v11
  s_add_u32 s62, s58, 262144
  s_add_u32 m0, s59, 4096
  s_nop 0
  buffer_load_dwordx4 v13, s[40:43], s62 offen nt lds
  v_xor_b32 v13, 64, v11
  s_add_u32 s62, s58, 327680
  s_add_u32 m0, s59, 5120
  s_nop 0
  buffer_load_dwordx4 v13, s[40:43], s62 offen nt lds
  v_xor_b32 v13, 96, v11
  s_add_u32 s62, s58, 393216
  s_add_u32 m0, s59, 6144
  s_nop 0
  buffer_load_dwordx4 v13, s[40:43], s62 offen nt lds
  v_xor_b32 v13, 96, v11
  s_add_u32 s62, s58, 458752
  s_add_u32 m0, s59, 7168
  s_nop 0
  buffer_load_dwordx4 v13, s[40:43], s62 offen nt lds
  v_xor_b32 v13, 0, v11
  s_add_u32 s62, s58, 524288
  s_add_u32 m0, s59, 8192
  s_nop 0
  buffer_load_dwordx4 v13, s[40:43], s62 offen nt lds
  v_xor_b32 v13, 0, v11
  s_add_u32 s62, s58, 589824
  s_add_u32 m0, s59, 9216
  s_nop 0
  buffer_load_dwordx4 v13, s[40:43], s62 offen nt lds
  v_xor_b32 v13, 32, v11
  s_add_u32 s62, s58, 655360
  s_add_u32 m0, s59, 10240
  s_nop 0
  buffer_load_dwordx4 v13, s[40:43], s62 offen nt lds
  v_xor_b32 v13, 32, v11
  s_add_u32 s62, s58, 720896
  s_add_u32 m0, s59, 11264
  s_nop 0
  buffer_load_dwordx4 v13, s[40:43], s62 offen nt lds
  v_xor_b32 v13, 64, v11
  s_add_u32 s62, s58, 786432
  s_add_u32 m0, s59, 12288
  s_nop 0
  buffer_load_dwordx4 v13, s[40:43], s62 offen nt lds
  v_xor_b32 v13, 64, v11
  s_add_u32 s62, s58, 851968
  s_add_u32 m0, s59, 13312
  s_nop 0
  buffer_load_dwordx4 v13, s[40:43], s62 offen nt lds
  v_xor_b32 v13, 96, v11
  s_add_u32 s62, s58, 917504
  s_add_u32 m0, s59, 14336
  s_nop 0
  buffer_load_dwordx4 v13, s[40:43], s62 offen nt lds
  v_xor_b32 v13, 96, v11
  s_add_u32 s62, s58, 983040
  s_add_u32 m0, s59, 15360
  s_nop 0
  buffer_load_dwordx4 v13, s[40:43], s62 offen nt lds
  v_mul_u32_u24 v39, 448, v14
  v_bfe_u32 v40, v0, 1, 1
  v_lshl_add_u32 v39, v40, 4, v39
  v_bfe_u32 v40, v0, 2, 1
  v_lshl_add_u32 v39, v40, 2, v39
  v_add_u32 v39, v39, v2
  s_min_u32 s62, s31, 27
  s_lshr_b32 s63, s62, 1
  s_lshl_b32 s63, s63, 5
  s_and_b32 s62, s62, 1
  s_lshl_b32 s62, s62, 3
  s_add_u32 s62, s62, s63
  v_add_u32 v39, s62, v39
  v_lshlrev_b32 v200, 1, v39
  global_load_ushort v201, v200, s[4:5]
  global_load_ushort v202, v200, s[24:25]
  s_cmp_ge_u32 s31, 112
  s_cbranch_scc1 L_wgu
  s_cmp_ge_u32 s3, 2
  s_cselect_b32 s36, s20, s18
  s_cselect_b32 s37, s21, s19
  s_mov_b32 s38, 1605632
  s_mov_b32 s39, 0x20000
  v_mul_u32_u24 v9, 3584, v7
  v_add_u32 v9, v9, v6
  s_and_b32 s53, s2, 3
  s_mul_i32 s55, s53, 401408
  s_lshr_b32 s54, s31, 2
  s_lshl_b32 s62, s54, 7
  s_add_u32 s55, s55, s62
  s_and_b32 s62, s3, 1
  s_mul_i32 s62, s62, 200704
  s_add_u32 s55, s55, s62
  s_mul_i32 s57, s3, 7168
  s_add_u32 s57, s57, 4096
  s_add_u32 m0, s57, 0
  s_nop 0
  buffer_load_dwordx4 v9, s[36:39], s55 offen nt lds
  s_add_u32 s55, s55, 28672
  s_add_u32 m0, s57, 1024
  s_nop 0
  buffer_load_dwordx4 v9, s[36:39], s55 offen nt lds
  s_add_u32 s55, s55, 28672
  s_add_u32 m0, s57, 2048
  s_nop 0
  buffer_load_dwordx4 v9, s[36:39], s55 offen nt lds
  s_add_u32 s55, s55, 28672
  s_add_u32 m0, s57, 3072
  s_nop 0
  buffer_load_dwordx4 v9, s[36:39], s55 offen nt lds
  s_add_u32 s55, s55, 28672
  s_add_u32 m0, s57, 4096
  s_nop 0
  buffer_load_dwordx4 v9, s[36:39], s55 offen nt lds
  s_add_u32 s55, s55, 28672
  s_add_u32 m0, s57, 5120
  s_nop 0
  buffer_load_dwordx4 v9, s[36:39], s55 offen nt lds
  s_add_u32 s55, s55, 28672
  s_add_u32 m0, s57, 6144
  s_nop 0
  buffer_load_dwordx4 v9, s[36:39], s55 offen nt lds
L_wgu:
  v_lshrrev_b32 v39, 2, v1
  v_lshl_add_u32 v40, v39, 4, v2
  v_lshlrev_b32 v40, 7, v40
  v_lshlrev_b32 v39, 1, v39
  v_bfe_u32 v41, v0, 1, 1
  v_xor_b32 v39, v39, v41
  v_lshl_add_u32 v40, v39, 4, v40
  v_lshl_add_u32 v40, v14, 3, v40
  v_add_u32 v41, s59, v40
  v_xor_b32 v42, 32, v41
  v_xor_b32 v43, 64, v41
  v_xor_b32 v52, 96, v41
  v_and_b32 v39, 3, v0
  v_lshlrev_b32 v39, 3, v39
  v_lshrrev_b32 v39, v39, v3
  v_bfe_u32 v24, v39, 0, 1
  v_bfe_u32 v13, v39, 1, 1
  v_lshl_or_b32 v24, v13, 16, v24
  v_bfe_u32 v25, v39, 2, 1
  v_bfe_u32 v13, v39, 3, 1
  v_lshl_or_b32 v25, v13, 16, v25
  v_bfe_u32 v26, v39, 4, 1
  v_bfe_u32 v13, v39, 5, 1
  v_lshl_or_b32 v26, v13, 16, v26
  v_bfe_u32 v27, v39, 6, 1
  v_bfe_u32 v13, v39, 7, 1
  v_lshl_or_b32 v27, v13, 16, v27
  s_waitcnt vmcnt(7)
  s_cmp_lt_u32 s31, 112
  s_cbranch_scc1 L_wst
  s_waitcnt vmcnt(0)
L_wst:
  ds_read_b64_tr_b16 a[64:65], v41 offset:0
  ds_read_b64_tr_b16 a[66:67], v41 offset:8192
  ds_read_b64_tr_b16 a[68:69], v41 offset:512
  ds_read_b64_tr_b16 a[70:71], v41 offset:8704
  ds_read_b64_tr_b16 a[72:73], v41 offset:1024
  ds_read_b64_tr_b16 a[74:75], v41 offset:9216
  ds_read_b64_tr_b16 a[76:77], v41 offset:1536
  ds_read_b64_tr_b16 a[78:79], v41 offset:9728
  ds_read_b64_tr_b16 a[80:81], v42 offset:0
  ds_read_b64_tr_b16 a[82:83], v42 offset:8192
  ds_read_b64_tr_b16 a[84:85], v42 offset:512
  ds_read_b64_tr_b16 a[86:87], v42 offset:8704
  ds_read_b64_tr_b16 a[88:89], v42 offset:1024
  ds_read_b64_tr_b16 a[90:91], v42 offset:9216
  ds_read_b64_tr_b16 a[92:93], v42 offset:1536
  ds_read_b64_tr_b16 a[94:95], v42 offset:9728
  ds_read_b64_tr_b16 a[96:97], v43 offset:0
  ds_read_b64_tr_b16 a[98:99], v43 offset:8192
  ds_read_b64_tr_b16 a[100:101], v43 offset:512
  ds_read_b64_tr_b16 a[102:103], v43 offset:8704
  ds_read_b64_tr_b16 a[104:105], v43 offset:1024
  ds_read_b64_tr_b16 a[106:107], v43 offset:9216
  ds_read_b64_tr_b16 a[108:109], v43 offset:1536
  ds_read_b64_tr_b16 a[110:111], v43 offset:9728
  ds_read_b64_tr_b16 a[112:113], v52 offset:0
  ds_read_b64_tr_b16 a[114:115], v52 offset:8192
  ds_read_b64_tr_b16 a[116:117], v52 offset:512
  ds_read_b64_tr_b16 a[118:119], v52 offset:8704
  ds_read_b64_tr_b16 a[120:121], v52 offset:1024
  ds_read_b64_tr_b16 a[122:123], v52 offset:9216
  ds_read_b64_tr_b16 a[124:125], v52 offset:1536
  ds_read_b64_tr_b16 a[126:127], v52 offset:9728
  s_cmp_ge_u32 s31, 112
  s_cbranch_scc1 L_wf1
  v_mul_u32_u24 v15, 896, v14
  v_lshl_add_u32 v15, v2, 3, v15
  s_and_b32 s62, s2, 3
  s_mul_i32 s62, s62, 224
  v_add_u32 v15, s62, v15
  ds_read_b64 v[176:177], v15 offset:0
  ds_read_b64 v[178:179], v15 offset:32
  ds_read_b64 v[180:181], v15 offset:64
  ds_read_b64 v[182:183], v15 offset:96
  ds_read_b64 v[184:185], v15 offset:128
  ds_read_b64 v[186:187], v15 offset:160
  ds_read_b64 v[188:189], v15 offset:192
  v_lshrrev_b32 v39, 2, v1
  v_lshl_add_u32 v39, v2, 2, v39
  v_and_b32 v40, 6, v39
  v_bfe_u32 v41, v0, 1, 1
  v_xor_b32 v40, v40, v41
  v_lshlrev_b32 v38, 7, v39
  v_lshl_add_u32 v38, v40, 4, v38
  v_lshl_add_u32 v38, v14, 3, v38
  v_add_u32 v38, 4096, v38
  s_lshl_b32 s62, s3, 5
  v_xor_b32 v38, s62, v38
  v_lshlrev_b32 v40, 4, v0
  v_lshlrev_b32 v41, 6, v2
  v_lshl_add_u32 v41, v1, 4, v41
  s_lshl_b32 s64, s54, 2
  s_add_u32 s64, s64, s3
  s_mul_i32 s64, s64, 16640
  s_lshl_b32 s63, s53, 8
  s_add_u32 s64, s64, s63
  s_add_u32 s64, s64, 2099200
  s_waitcnt vmcnt(0) lgkmcnt(0)
  s_barrier
  ds_read_b64_tr_b16 v[208:209], v38 offset:0
  ds_read_b64_tr_b16 v[210:211], v38 offset:2048
  ds_read_b64_tr_b16 v[212:213], v38 offset:4096
  ds_read_b64_tr_b16 v[214:215], v38 offset:6144
  ds_read_b64_tr_b16 v[216:217], v38 offset:8192
  ds_read_b64_tr_b16 v[218:219], v38 offset:10240
  ds_read_b64_tr_b16 v[220:221], v38 offset:12288
  ds_read_b64_tr_b16 v[222:223], v38 offset:14336
  ds_read_b64_tr_b16 v[224:225], v38 offset:16384
  ds_read_b64_tr_b16 v[226:227], v38 offset:18432
  ds_read_b64_tr_b16 v[228:229], v38 offset:20480
  ds_read_b64_tr_b16 v[230:231], v38 offset:22528
  ds_read_b64_tr_b16 v[232:233], v38 offset:24576
  ds_read_b64_tr_b16 v[234:235], v38 offset:26624
  s_waitcnt lgkmcnt(13)
  v_mfma_f32_16x16x16_bf16 v[128:131], v[208:209], v[176:177], 0
  s_waitcnt lgkmcnt(12)
  v_mfma_f32_16x16x16_bf16 v[128:131], v[210:211], v[178:179], v[128:131]
  s_waitcnt lgkmcnt(11)
  v_mfma_f32_16x16x16_bf16 v[128:131], v[212:213], v[180:181], v[128:131]
  s_waitcnt lgkmcnt(10)
  v_mfma_f32_16x16x16_bf16 v[128:131], v[214:215], v[182:183], v[128:131]
  s_waitcnt lgkmcnt(9)
  v_mfma_f32_16x16x16_bf16 v[128:131], v[216:217], v[184:185], v[128:131]
  s_waitcnt lgkmcnt(8)
  v_mfma_f32_16x16x16_bf16 v[128:131], v[218:219], v[186:187], v[128:131]
  s_waitcnt lgkmcnt(7)
  v_mfma_f32_16x16x16_bf16 v[128:131], v[220:221], v[188:189], v[128:131]
  s_waitcnt lgkmcnt(6)
  v_mfma_f32_16x16x16_bf16 v[132:135], v[222:223], v[176:177], 0
  s_waitcnt lgkmcnt(5)
  v_mfma_f32_16x16x16_bf16 v[132:135], v[224:225], v[178:179], v[132:135]
  s_waitcnt lgkmcnt(4)
  v_mfma_f32_16x16x16_bf16 v[132:135], v[226:227], v[180:181], v[132:135]
  s_waitcnt lgkmcnt(3)
  v_mfma_f32_16x16x16_bf16 v[132:135], v[228:229], v[182:183], v[132:135]
  s_waitcnt lgkmcnt(2)
  v_mfma_f32_16x16x16_bf16 v[132:135], v[230:231], v[184:185], v[132:135]
  s_waitcnt lgkmcnt(1)
  v_mfma_f32_16x16x16_bf16 v[132:135], v[232:233], v[186:187], v[132:135]
  s_waitcnt lgkmcnt(0)
  v_mfma_f32_16x16x16_bf16 v[132:135], v[234:235], v[188:189], v[132:135]
  v_perm_b32 v48, v128, v3, s44
  v_perm_b32 v49, v129, v3, s45
  v_perm_b32 v50, v130, v3, s46
  v_perm_b32 v51, v131, v3, s47
  s_mov_b32 exec_lo, 0xc000c
  s_mov_b32 exec_hi, 0xc000c
  s_nop 1
  v_perm_b32 v48, v132, v3, s44
  v_perm_b32 v49, v133, v3, s45
  v_perm_b32 v50, v134, v3, s46
  v_perm_b32 v51, v135, v3, s47
  s_mov_b32 exec_lo, 0xf000f
  s_mov_b32 exec_hi, 0xf000f
  buffer_store_dwordx4 v[48:51], v41, s[32:35], s64 offen sc1
  s_mov_b64 exec, -1
  s_nop 0
L_wf1:
  v_lshlrev_b32 v40, 4, v0
  v_and_b32 v41, 31, v0
  v_mul_u32_u24 v41, 16640, v41
  s_mul_i32 s97, s3, 532480
  s_lshl_b32 s62, s60, 4
  s_add_u32 s97, s97, s62
  s_add_u32 s97, s97, 2101248
  s_mul_i32 s56, s31, 33024
  s_lshl_b32 s57, s3, 13
  s_add_u32 s56, s56, s57
  s_add_u32 s56, s56, 8388608
  s_add_u32 s57, s56, 4096
  v_lshlrev_b32 v61, 2, v2
  v_and_b32 v62, 3, v0
  v_lshlrev_b32 v62, 4, v62
  v_and_b32 v55, 12, v0
  v_add3_u32 v62, v62, v55, v2
  v_lshlrev_b32 v62, 4, v62
  s_lshl_b32 s62, s3, 10
  s_add_u32 s62, s62, 32768
  v_add_u32 v62, s62, v62
  v_lshlrev_b32 v58, 5, v14
  s_lshl_b32 s62, s3, 3
  v_add_u32 v59, s62, v58
  v_lshlrev_b32 v60, 6, v2
  v_lshl_add_u32 v60, v1, 4, v60
  s_lshl_b32 s58, s60, 3
  s_lshl_b32 s63, s3, 1
  s_add_u32 s58, s58, s63
  s_mul_i32 s58, s58, 16640
  s_lshl_b32 s63, s61, 8
  s_add_u32 s58, s58, s63
  s_add_u32 s58, s58, 2097152
  s_add_u32 s65, s58, 16640
  s_mul_i32 s66, s31, 16640
  s_lshl_b32 s62, s3, 6
  s_add_u32 s66, s66, s62
  s_add_u32 s66, s66, 2101504
  s_add_u32 s70, s28, s66
  s_addc_u32 s71, s29, 0
  s_mov_b32 s96, 400000
L_wl:
  s_load_dword s72, s[70:71], 0 glc
  s_sub_u32 s96, s96, 1
  s_cbranch_scc1 L_end
  s_waitcnt lgkmcnt(0)
  s_cmp_lg_u32 s72, s30
  s_cbranch_scc1 L_wl
  buffer_load_dwordx4 v[44:47], v41, s[32:35], s97 offen sc1
  buffer_load_dwordx4 v[64:67], v40, s[32:35], s56 offen offset:0 sc1
  buffer_load_dwordx4 v[68:71], v40, s[32:35], s56 offen offset:1024 sc1
  buffer_load_dwordx4 v[72:75], v40, s[32:35], s56 offen offset:2048 sc1
  buffer_load_dwordx4 v[76:79], v40, s[32:35], s56 offen offset:3072 sc1
  buffer_load_dwordx4 v[80:83], v40, s[32:35], s57 offen offset:0 sc1
  buffer_load_dwordx4 v[84:87], v40, s[32:35], s57 offen offset:1024 sc1
  buffer_load_dwordx4 v[88:91], v40, s[32:35], s57 offen offset:2048 sc1
  buffer_load_dwordx4 v[92:95], v40, s[32:35], s57 offen offset:3072 sc1
L_wlr:
  s_waitcnt vmcnt(8)
  v_cmp_ne_u32 s[68:69], v46, v3
  v_mov_b32 v46, v44
  s_nop 1
  v_max_f32_dpp v46, v46, v46 row_ror:8 row_mask:0xf bank_mask:0xf
  s_nop 1
  v_max_f32_dpp v46, v46, v46 row_ror:4 row_mask:0xf bank_mask:0xf
  s_nop 1
  v_max_f32_dpp v46, v46, v46 row_ror:2 row_mask:0xf bank_mask:0xf
  v_mov_b32 v55, v46
  s_nop 1
  v_permlane16_swap_b32 v55, v46
  v_max_f32 v46, v46, v55
  v_sub_f32 v44, v44, v46
  v_exp_f32 v44, v44
  s_nop 0
  ds_bpermute_b32 v100, v61, v44 offset:0
  ds_bpermute_b32 v101, v61, v44 offset:16
  ds_bpermute_b32 v102, v61, v44 offset:32
  ds_bpermute_b32 v103, v61, v44 offset:48
  ds_bpermute_b32 v104, v61, v44 offset:64
  ds_bpermute_b32 v105, v61, v44 offset:80
  ds_bpermute_b32 v106, v61, v44 offset:96
  ds_bpermute_b32 v107, v61, v44 offset:112
  v_mul_f32 v47, v45, v44
  s_nop 1
  v_add_f32_dpp v47, v47, v47 row_ror:8 row_mask:0xf bank_mask:0xf
  s_nop 1
  v_add_f32_dpp v47, v47, v47 row_ror:4 row_mask:0xf bank_mask:0xf
  s_nop 1
  v_add_f32_dpp v47, v47, v47 row_ror:2 row_mask:0xf bank_mask:0xf
  v_mov_b32 v55, v47
  s_nop 1
  v_permlane16_swap_b32 v55, v47
  v_add_f32 v47, v47, v55
  ds_write_b64 v59, v[46:47] offset:36864
  s_waitcnt lgkmcnt(1)
  s_waitcnt vmcnt(7)
  v_lshlrev_b32 v56, 16, v64
  v_and_b32 v57, 0xffff0000, v64
  v_xor_b32 v55, v64, v24
  v_mul_f32 v110, v56, v100
  v_mul_f32 v111, v57, v100
  v_lshlrev_b32 v56, 16, v65
  v_and_b32 v57, 0xffff0000, v65
  v_bitop3_b32 v55, v65, v25, v55 bitop3:0xbe
  v_mul_f32 v112, v56, v100
  v_mul_f32 v113, v57, v100
  v_lshlrev_b32 v56, 16, v66
  v_and_b32 v57, 0xffff0000, v66
  v_bitop3_b32 v55, v66, v26, v55 bitop3:0xbe
  v_mul_f32 v114, v56, v100
  v_mul_f32 v115, v57, v100
  v_lshlrev_b32 v56, 16, v67
  v_and_b32 v57, 0xffff0000, v67
  v_bitop3_b32 v55, v67, v27, v55 bitop3:0xbe
  v_mul_f32 v116, v56, v100
  v_mul_f32 v117, v57, v100
  s_waitcnt vmcnt(6)
  v_lshlrev_b32 v56, 16, v68
  v_and_b32 v57, 0xffff0000, v68
  v_bitop3_b32 v55, v68, v24, v55 bitop3:0xbe
  v_fmac_f32 v110, v56, v101
  v_fmac_f32 v111, v57, v101
  v_lshlrev_b32 v56, 16, v69
  v_and_b32 v57, 0xffff0000, v69
  v_bitop3_b32 v55, v69, v25, v55 bitop3:0xbe
  v_fmac_f32 v112, v56, v101
  v_fmac_f32 v113, v57, v101
  v_lshlrev_b32 v56, 16, v70
  v_and_b32 v57, 0xffff0000, v70
  v_bitop3_b32 v55, v70, v26, v55 bitop3:0xbe
  v_fmac_f32 v114, v56, v101
  v_fmac_f32 v115, v57, v101
  v_lshlrev_b32 v56, 16, v71
  v_and_b32 v57, 0xffff0000, v71
  v_bitop3_b32 v55, v71, v27, v55 bitop3:0xbe
  v_fmac_f32 v116, v56, v101
  v_fmac_f32 v117, v57, v101
  s_waitcnt vmcnt(5)
  v_lshlrev_b32 v56, 16, v72
  v_and_b32 v57, 0xffff0000, v72
  v_bitop3_b32 v55, v72, v24, v55 bitop3:0xbe
  v_fmac_f32 v110, v56, v102
  v_fmac_f32 v111, v57, v102
  v_lshlrev_b32 v56, 16, v73
  v_and_b32 v57, 0xffff0000, v73
  v_bitop3_b32 v55, v73, v25, v55 bitop3:0xbe
  v_fmac_f32 v112, v56, v102
  v_fmac_f32 v113, v57, v102
  v_lshlrev_b32 v56, 16, v74
  v_and_b32 v57, 0xffff0000, v74
  v_bitop3_b32 v55, v74, v26, v55 bitop3:0xbe
  v_fmac_f32 v114, v56, v102
  v_fmac_f32 v115, v57, v102
  v_lshlrev_b32 v56, 16, v75
  v_and_b32 v57, 0xffff0000, v75
  v_bitop3_b32 v55, v75, v27, v55 bitop3:0xbe
  v_fmac_f32 v116, v56, v102
  v_fmac_f32 v117, v57, v102
  s_waitcnt vmcnt(4)
  v_lshlrev_b32 v56, 16, v76
  v_and_b32 v57, 0xffff0000, v76
  v_bitop3_b32 v55, v76, v24, v55 bitop3:0xbe
  v_fmac_f32 v110, v56, v103
  v_fmac_f32 v111, v57, v103
  v_lshlrev_b32 v56, 16, v77
  v_and_b32 v57, 0xffff0000, v77
  v_bitop3_b32 v55, v77, v25, v55 bitop3:0xbe
  v_fmac_f32 v112, v56, v103
  v_fmac_f32 v113, v57, v103
  v_lshlrev_b32 v56, 16, v78
  v_and_b32 v57, 0xffff0000, v78
  v_bitop3_b32 v55, v78, v26, v55 bitop3:0xbe
  v_fmac_f32 v114, v56, v103
  v_fmac_f32 v115, v57, v103
  v_lshlrev_b32 v56, 16, v79
  v_and_b32 v57, 0xffff0000, v79
  v_bitop3_b32 v55, v79, v27, v55 bitop3:0xbe
  v_fmac_f32 v116, v56, v103
  v_fmac_f32 v117, v57, v103
  s_waitcnt vmcnt(3)
  v_lshlrev_b32 v56, 16, v80
  v_and_b32 v57, 0xffff0000, v80
  v_bitop3_b32 v55, v80, v24, v55 bitop3:0xbe
  v_fmac_f32 v110, v56, v104
  v_fmac_f32 v111, v57, v104
  v_lshlrev_b32 v56, 16, v81
  v_and_b32 v57, 0xffff0000, v81
  v_bitop3_b32 v55, v81, v25, v55 bitop3:0xbe
  v_fmac_f32 v112, v56, v104
  v_fmac_f32 v113, v57, v104
  v_lshlrev_b32 v56, 16, v82
  v_and_b32 v57, 0xffff0000, v82
  v_bitop3_b32 v55, v82, v26, v55 bitop3:0xbe
  v_fmac_f32 v114, v56, v104
  v_fmac_f32 v115, v57, v104
  v_lshlrev_b32 v56, 16, v83
  v_and_b32 v57, 0xffff0000, v83
  v_bitop3_b32 v55, v83, v27, v55 bitop3:0xbe
  v_fmac_f32 v116, v56, v104
  v_fmac_f32 v117, v57, v104
  s_waitcnt vmcnt(2)
  v_lshlrev_b32 v56, 16, v84
  v_and_b32 v57, 0xffff0000, v84
  v_bitop3_b32 v55, v84, v24, v55 bitop3:0xbe
  v_fmac_f32 v110, v56, v105
  v_fmac_f32 v111, v57, v105
  v_lshlrev_b32 v56, 16, v85
  v_and_b32 v57, 0xffff0000, v85
  v_bitop3_b32 v55, v85, v25, v55 bitop3:0xbe
  v_fmac_f32 v112, v56, v105
  v_fmac_f32 v113, v57, v105
  v_lshlrev_b32 v56, 16, v86
  v_and_b32 v57, 0xffff0000, v86
  v_bitop3_b32 v55, v86, v26, v55 bitop3:0xbe
  v_fmac_f32 v114, v56, v105
  v_fmac_f32 v115, v57, v105
  v_lshlrev_b32 v56, 16, v87
  v_and_b32 v57, 0xffff0000, v87
  v_bitop3_b32 v55, v87, v27, v55 bitop3:0xbe
  v_fmac_f32 v116, v56, v105
  v_fmac_f32 v117, v57, v105
  s_waitcnt vmcnt(1)
  v_lshlrev_b32 v56, 16, v88
  v_and_b32 v57, 0xffff0000, v88
  v_bitop3_b32 v55, v88, v24, v55 bitop3:0xbe
  v_fmac_f32 v110, v56, v106
  v_fmac_f32 v111, v57, v106
  v_lshlrev_b32 v56, 16, v89
  v_and_b32 v57, 0xffff0000, v89
  v_bitop3_b32 v55, v89, v25, v55 bitop3:0xbe
  v_fmac_f32 v112, v56, v106
  v_fmac_f32 v113, v57, v106
  v_lshlrev_b32 v56, 16, v90
  v_and_b32 v57, 0xffff0000, v90
  v_bitop3_b32 v55, v90, v26, v55 bitop3:0xbe
  v_fmac_f32 v114, v56, v106
  v_fmac_f32 v115, v57, v106
  v_lshlrev_b32 v56, 16, v91
  v_and_b32 v57, 0xffff0000, v91
  v_bitop3_b32 v55, v91, v27, v55 bitop3:0xbe
  v_fmac_f32 v116, v56, v106
  v_fmac_f32 v117, v57, v106
  s_waitcnt vmcnt(0)
  v_lshlrev_b32 v56, 16, v92
  v_and_b32 v57, 0xffff0000, v92
  v_bitop3_b32 v55, v92, v24, v55 bitop3:0xbe
  v_fmac_f32 v110, v56, v107
  v_fmac_f32 v111, v57, v107
  v_lshlrev_b32 v56, 16, v93
  v_and_b32 v57, 0xffff0000, v93
  v_bitop3_b32 v55, v93, v25, v55 bitop3:0xbe
  v_fmac_f32 v112, v56, v107
  v_fmac_f32 v113, v57, v107
  v_lshlrev_b32 v56, 16, v94
  v_and_b32 v57, 0xffff0000, v94
  v_bitop3_b32 v55, v94, v26, v55 bitop3:0xbe
  v_fmac_f32 v114, v56, v107
  v_fmac_f32 v115, v57, v107
  v_lshlrev_b32 v56, 16, v95
  v_and_b32 v57, 0xffff0000, v95
  v_bitop3_b32 v55, v95, v27, v55 bitop3:0xbe
  v_fmac_f32 v116, v56, v107
  v_fmac_f32 v117, v57, v107
  v_and_b32 v55, 0x10001, v55
  v_cmp_ne_u32 vcc, 0, v55
  s_nop 0
  s_or_b64 vcc, vcc, s[68:69]
  s_cbranch_vccz L_wlk
  s_waitcnt lgkmcnt(0)
  buffer_load_dwordx4 v[44:47], v41, s[32:35], s97 offen sc1
  buffer_load_dwordx4 v[64:67], v40, s[32:35], s56 offen offset:0 sc1
  buffer_load_dwordx4 v[68:71], v40, s[32:35], s56 offen offset:1024 sc1
  buffer_load_dwordx4 v[72:75], v40, s[32:35], s56 offen offset:2048 sc1
  buffer_load_dwordx4 v[76:79], v40, s[32:35], s56 offen offset:3072 sc1
  buffer_load_dwordx4 v[80:83], v40, s[32:35], s57 offen offset:0 sc1
  buffer_load_dwordx4 v[84:87], v40, s[32:35], s57 offen offset:1024 sc1
  buffer_load_dwordx4 v[88:91], v40, s[32:35], s57 offen offset:2048 sc1
  buffer_load_dwordx4 v[92:95], v40, s[32:35], s57 offen offset:3072 sc1
  s_sub_u32 s96, s96, 1
  s_cbranch_scc1 L_end
  s_branch L_wlr
L_wlk:
  v_permlane32_swap_b32 v110, v114
  v_permlane32_swap_b32 v111, v115
  v_permlane32_swap_b32 v112, v116
  v_permlane32_swap_b32 v113, v117
  v_add_f32 v120, v110, v114
  v_add_f32 v121, v111, v115
  v_add_f32 v122, v112, v116
  v_add_f32 v123, v113, v117
  ds_write_b128 v62, v[120:123]
  s_waitcnt lgkmcnt(0)
  s_barrier
  ds_read_b128 v[44:47], v58 offset:36864
  ds_read_b128 v[48:51], v58 offset:36880
  ds_read_b128 v[64:67], v40 offset:32768
  ds_read_b128 v[68:71], v40 offset:33792
  ds_read_b128 v[72:75], v40 offset:34816
  ds_read_b128 v[76:79], v40 offset:35840
  s_waitcnt lgkmcnt(4)
  v_max3_f32 v55, v44, v46, v48
  v_max_f32 v55, v55, v50
  v_sub_f32 v44, v44, v55
  v_sub_f32 v46, v46, v55
  v_sub_f32 v48, v48, v55
  v_sub_f32 v50, v50, v55
  v_exp_f32 v44, v44
  v_exp_f32 v46, v46
  v_exp_f32 v48, v48
  v_exp_f32 v50, v50
  v_mul_f32 v55, v44, v45
  v_fmac_f32 v55, v46, v47
  v_fmac_f32 v55, v48, v49
  v_fmac_f32 v55, v50, v51
  v_rcp_f32 v55, v55
  s_waitcnt lgkmcnt(0)
  v_mul_f32 v64, v64, v44
  v_mul_f32 v65, v65, v44
  v_mul_f32 v66, v66, v44
  v_mul_f32 v67, v67, v44
  v_fmac_f32 v64, v68, v46
  v_fmac_f32 v65, v69, v46
  v_fmac_f32 v66, v70, v46
  v_fmac_f32 v67, v71, v46
  v_fmac_f32 v64, v72, v48
  v_fmac_f32 v65, v73, v48
  v_fmac_f32 v66, v74, v48
  v_fmac_f32 v67, v75, v48
  v_fmac_f32 v64, v76, v50
  v_fmac_f32 v65, v77, v50
  v_fmac_f32 v66, v78, v50
  v_fmac_f32 v67, v79, v50
  v_mul_f32 v64, v64, v55
  v_mul_f32 v65, v65, v55
  v_mul_f32 v66, v66, v55
  v_mul_f32 v67, v67, v55
  v_cvt_pk_bf16_f32 v78, v64, v65
  v_cvt_pk_bf16_f32 v79, v66, v67
  s_nop 0
  v_mov_b32_dpp v80, v78 quad_perm:[0,1,0,1] row_mask:0xf bank_mask:0xf
  v_mov_b32_dpp v81, v79 quad_perm:[0,1,0,1] row_mask:0xf bank_mask:0xf
  v_mov_b32_dpp v82, v78 quad_perm:[2,3,2,3] row_mask:0xf bank_mask:0xf
  v_mov_b32_dpp v83, v79 quad_perm:[2,3,2,3] row_mask:0xf bank_mask:0xf
  v_mov_b32_dpp v84, v80 row_shl:4 row_mask:0xf bank_mask:0xf
  v_mov_b32_dpp v85, v81 row_shl:4 row_mask:0xf bank_mask:0xf
  v_mov_b32_dpp v86, v82 row_shl:4 row_mask:0xf bank_mask:0xf
  v_mov_b32_dpp v87, v83 row_shl:4 row_mask:0xf bank_mask:0xf
  v_mov_b32_dpp v88, v80 row_shl:8 row_mask:0xf bank_mask:0xf
  v_mov_b32_dpp v89, v81 row_shl:8 row_mask:0xf bank_mask:0xf
  v_mov_b32_dpp v90, v82 row_shl:8 row_mask:0xf bank_mask:0xf
  v_mov_b32_dpp v91, v83 row_shl:8 row_mask:0xf bank_mask:0xf
  v_mov_b32_dpp v92, v80 row_shl:12 row_mask:0xf bank_mask:0xf
  v_mov_b32_dpp v93, v81 row_shl:12 row_mask:0xf bank_mask:0xf
  v_mov_b32_dpp v94, v82 row_shl:12 row_mask:0xf bank_mask:0xf
  v_mov_b32_dpp v95, v83 row_shl:12 row_mask:0xf bank_mask:0xf
  v_mfma_f32_16x16x32_bf16 v[100:103], a[64:67], v[80:83], 0
  v_mfma_f32_16x16x32_bf16 v[104:107], a[80:83], v[80:83], 0
  v_mfma_f32_16x16x32_bf16 v[108:111], a[96:99], v[80:83], 0
  v_mfma_f32_16x16x32_bf16 v[112:115], a[112:115], v[80:83], 0
  v_mfma_f32_16x16x32_bf16 v[100:103], a[68:71], v[84:87], v[100:103]
  v_mfma_f32_16x16x32_bf16 v[104:107], a[84:87], v[84:87], v[104:107]
  v_mfma_f32_16x16x32_bf16 v[108:111], a[100:103], v[84:87], v[108:111]
  v_mfma_f32_16x16x32_bf16 v[112:115], a[116:119], v[84:87], v[112:115]
  v_mfma_f32_16x16x32_bf16 v[100:103], a[72:75], v[88:91], v[100:103]
  v_mfma_f32_16x16x32_bf16 v[104:107], a[88:91], v[88:91], v[104:107]
  v_mfma_f32_16x16x32_bf16 v[108:111], a[104:107], v[88:91], v[108:111]
  v_mfma_f32_16x16x32_bf16 v[112:115], a[120:123], v[88:91], v[112:115]
  v_mfma_f32_16x16x32_bf16 v[100:103], a[76:79], v[92:95], v[100:103]
  v_mfma_f32_16x16x32_bf16 v[104:107], a[92:95], v[92:95], v[104:107]
  v_mfma_f32_16x16x32_bf16 v[108:111], a[108:111], v[92:95], v[108:111]
  v_mfma_f32_16x16x32_bf16 v[112:115], a[124:127], v[92:95], v[112:115]
  s_nop 4
  v_perm_b32 v64, v100, v3, s44
  v_perm_b32 v65, v101, v3, s45
  v_perm_b32 v66, v102, v3, s46
  v_perm_b32 v67, v103, v3, s47
  v_perm_b32 v68, v108, v3, s44
  v_perm_b32 v69, v109, v3, s45
  v_perm_b32 v70, v110, v3, s46
  v_perm_b32 v71, v111, v3, s47
  s_mov_b32 exec_lo, 0xc000c
  s_mov_b32 exec_hi, 0xc000c
  v_perm_b32 v64, v104, v3, s44
  v_perm_b32 v65, v105, v3, s45
  v_perm_b32 v66, v106, v3, s46
  v_perm_b32 v67, v107, v3, s47
  v_perm_b32 v68, v112, v3, s44
  v_perm_b32 v69, v113, v3, s45
  v_perm_b32 v70, v114, v3, s46
  v_perm_b32 v71, v115, v3, s47
  s_mov_b32 exec_lo, 0xf000f
  s_mov_b32 exec_hi, 0xf000f
  buffer_store_dwordx4 v[64:67], v60, s[32:35], s58 offen sc1
  buffer_store_dwordx4 v[68:71], v60, s[32:35], s65 offen sc1
  s_mov_b64 exec, -1
  s_cmp_ge_u32 s31, 28
  s_cbranch_scc1 L_end
  v_lshlrev_b32 v57, 2, v0
  s_lshl_b32 s62, s3, 8
  v_add_u32 v56, s62, v57
  s_mul_i32 s62, s31, 73984
  s_lshl_b32 s63, s3, 12
  s_add_u32 s64, s62, s63
  s_add_u32 s62, s64, 5259264
  s_add_u32 s64, s64, 5242880
  v_mov_b32 v88, 0
  v_mov_b32 v89, 0
  v_mov_b32 v90, 0
  v_mov_b32 v91, 0
  v_mov_b32 v92, 0
  v_mov_b32 v93, 0
  v_mov_b32 v94, 0
  v_mov_b32 v95, 0
  s_mov_b32 s96, 400000
L_fy:
  buffer_load_dwordx4 v[80:83], v40, s[32:35], s62 offen offset:0 sc1
  buffer_load_dwordx4 v[84:87], v40, s[32:35], s62 offen offset:1024 sc1
  v_mov_b32 v55, 0
  s_cmp_eq_u32 s3, 3
  s_cbranch_scc1 L_fy_s
  buffer_load_dwordx4 v[88:91], v40, s[32:35], s62 offen offset:2048 sc1
  buffer_load_dwordx4 v[92:95], v40, s[32:35], s62 offen offset:3072 sc1
  s_waitcnt vmcnt(0)
  v_perm_b32 v53, v89, v88, s48
  v_perm_b32 v54, v91, v90, s49
  v_or_b32 v53, v53, v54
  v_xor_b32 v55, v53, v3
  v_perm_b32 v53, v93, v92, s48
  v_perm_b32 v54, v95, v94, s49
  v_or_b32 v53, v53, v54
  v_xor_b32 v53, v53, v3
  v_or_b32 v55, v55, v53
L_fy_s:
  s_waitcnt vmcnt(0)
  v_perm_b32 v53, v81, v80, s48
  v_perm_b32 v54, v83, v82, s49
  v_or_b32 v53, v53, v54
  v_xor_b32 v53, v53, v3
  v_or_b32 v55, v55, v53
  v_perm_b32 v53, v85, v84, s48
  v_perm_b32 v54, v87, v86, s49
  v_or_b32 v53, v53, v54
  v_xor_b32 v53, v53, v3
  v_or_b32 v55, v55, v53
  v_cmp_ne_u32 vcc, 0, v55
  s_sub_u32 s96, s96, 1
  s_cbranch_scc1 L_end
  s_cbranch_vccnz L_fy
  v_add_f32 v72, v80, v84
  v_add_f32 v76, v88, v92
  v_add_f32 v73, v81, v85
  v_add_f32 v77, v89, v93
  v_add_f32 v74, v82, v86
  v_add_f32 v78, v90, v94
  v_add_f32 v75, v83, v87
  v_add_f32 v79, v91, v95
  v_add_f32 v72, v72, v76
  v_add_f32 v73, v73, v77
  v_add_f32 v74, v74, v78
  v_add_f32 v75, v75, v79
  v_add_f32_dpp v72, v72, v72 row_ror:8 row_mask:0xf bank_mask:0xf
  v_add_f32_dpp v73, v73, v73 row_ror:8 row_mask:0xf bank_mask:0xf
  v_add_f32_dpp v74, v74, v74 row_ror:8 row_mask:0xf bank_mask:0xf
  v_add_f32_dpp v75, v75, v75 row_ror:8 row_mask:0xf bank_mask:0xf
  s_nop 0
  v_permlane32_swap_b32 v72, v74
  v_permlane32_swap_b32 v73, v75
  v_add_f32 v72, v72, v74
  v_add_f32 v73, v73, v75
  s_nop 1
  v_permlane16_swap_b32 v72, v73
  v_add_f32 v72, v72, v73
  ds_write_b32 v56, v72 offset:40960
  s_mov_b32 s96, 400000
  buffer_load_dwordx4 v[80:83], v40, s[32:35], s64 offen offset:0 sc1
  buffer_load_dwordx4 v[84:87], v40, s[32:35], s64 offen offset:1024 sc1
  buffer_load_dwordx4 v[88:91], v40, s[32:35], s64 offen offset:2048 sc1
  buffer_load_dwordx4 v[92:95], v40, s[32:35], s64 offen offset:3072 sc1
  s_sleep 1
L_fo:
  buffer_load_dwordx4 v[96:99], v40, s[32:35], s64 offen offset:0 sc1
  buffer_load_dwordx4 v[100:103], v40, s[32:35], s64 offen offset:1024 sc1
  buffer_load_dwordx4 v[104:107], v40, s[32:35], s64 offen offset:2048 sc1
  buffer_load_dwordx4 v[108:111], v40, s[32:35], s64 offen offset:3072 sc1
  s_waitcnt vmcnt(4)
  v_perm_b32 v53, v81, v80, s48
  v_perm_b32 v54, v83, v82, s49
  v_or_b32 v53, v53, v54
  v_xor_b32 v55, v53, v3
  v_perm_b32 v53, v85, v84, s48
  v_perm_b32 v54, v87, v86, s49
  v_or_b32 v53, v53, v54
  v_xor_b32 v53, v53, v3
  v_or_b32 v55, v55, v53
  v_perm_b32 v53, v89, v88, s48
  v_perm_b32 v54, v91, v90, s49
  v_or_b32 v53, v53, v54
  v_xor_b32 v53, v53, v3
  v_or_b32 v55, v55, v53
  v_perm_b32 v53, v93, v92, s48
  v_perm_b32 v54, v95, v94, s49
  v_or_b32 v53, v53, v54
  v_xor_b32 v53, v53, v3
  v_or_b32 v55, v55, v53
  v_cmp_ne_u32 vcc, 0, v55
  s_cbranch_vccz L_fo_x
  buffer_load_dwordx4 v[80:83], v40, s[32:35], s64 offen offset:0 sc1
  buffer_load_dwordx4 v[84:87], v40, s[32:35], s64 offen offset:1024 sc1
  buffer_load_dwordx4 v[88:91], v40, s[32:35], s64 offen offset:2048 sc1
  buffer_load_dwordx4 v[92:95], v40, s[32:35], s64 offen offset:3072 sc1
  s_sub_u32 s96, s96, 1
  s_cbranch_scc1 L_end
  s_waitcnt vmcnt(4)
  v_perm_b32 v53, v97, v96, s48
  v_perm_b32 v54, v99, v98, s49
  v_or_b32 v53, v53, v54
  v_xor_b32 v55, v53, v3
  v_perm_b32 v53, v101, v100, s48
  v_perm_b32 v54, v103, v102, s49
  v_or_b32 v53, v53, v54
  v_xor_b32 v53, v53, v3
  v_or_b32 v55, v55, v53
  v_perm_b32 v53, v105, v104, s48
  v_perm_b32 v54, v107, v106, s49
  v_or_b32 v53, v53, v54
  v_xor_b32 v53, v53, v3
  v_or_b32 v55, v55, v53
  v_perm_b32 v53, v109, v108, s48
  v_perm_b32 v54, v111, v110, s49
  v_or_b32 v53, v53, v54
  v_xor_b32 v53, v53, v3
  v_or_b32 v55, v55, v53
  v_cmp_ne_u32 vcc, 0, v55
  s_cbranch_vccnz L_fo
  v_add_f32 v72, v96, v100
  v_add_f32 v76, v104, v108
  v_add_f32 v73, v97, v101
  v_add_f32 v77, v105, v109
  v_add_f32 v74, v98, v102
  v_add_f32 v78, v106, v110
  v_add_f32 v75, v99, v103
  v_add_f32 v79, v107, v111
  s_branch L_fo_j
L_fo_x:
  v_add_f32 v72, v80, v84
  v_add_f32 v76, v88, v92
  v_add_f32 v73, v81, v85
  v_add_f32 v77, v89, v93
  v_add_f32 v74, v82, v86
  v_add_f32 v78, v90, v94
  v_add_f32 v75, v83, v87
  v_add_f32 v79, v91, v95
L_fo_j:
  v_add_f32 v72, v72, v76
  v_add_f32 v73, v73, v77
  v_add_f32 v74, v74, v78
  v_add_f32 v75, v75, v79
  v_add_f32_dpp v72, v72, v72 row_ror:8 row_mask:0xf bank_mask:0xf
  v_add_f32_dpp v73, v73, v73 row_ror:8 row_mask:0xf bank_mask:0xf
  v_add_f32_dpp v74, v74, v74 row_ror:8 row_mask:0xf bank_mask:0xf
  v_add_f32_dpp v75, v75, v75 row_ror:8 row_mask:0xf bank_mask:0xf
  s_nop 0
  v_permlane32_swap_b32 v72, v74
  v_permlane32_swap_b32 v73, v75
  v_add_f32 v72, v72, v74
  v_add_f32 v73, v73, v75
  s_nop 1
  v_permlane16_swap_b32 v72, v73
  v_add_f32 v72, v72, v73
  ds_write_b32 v56, v72 offset:41984
  s_waitcnt lgkmcnt(0)
  s_barrier
  s_cmp_lg_u32 s3, 0
  s_cbranch_scc1 L_end
  ds_read_b32 v64, v57 offset:40960
  ds_read_b32 v68, v57 offset:41984
  ds_read_b32 v65, v57 offset:41216
  ds_read_b32 v69, v57 offset:42240
  ds_read_b32 v66, v57 offset:41472
  ds_read_b32 v70, v57 offset:42496
  ds_read_b32 v67, v57 offset:41728
  ds_read_b32 v71, v57 offset:42752
  s_mov_b32 s36, s24
  s_mov_b32 s37, s25
  s_mov_b32 s38, 1792
  s_mov_b32 s39, 0x20000
  s_waitcnt lgkmcnt(0)
  v_add_f32 v64, v64, v65
  v_add_f32 v66, v66, v67
  v_add_f32 v68, v68, v69
  v_add_f32 v70, v70, v71
  v_add_f32 v64, v64, v66
  v_add_f32 v68, v68, v70
  v_cvt_pk_bf16_f32 v64, v64, v64
  v_and_b32 v64, 0xffff0000, v64
  v_cvt_pk_bf16_f32 v68, v68, v68
  v_and_b32 v68, 0xffff0000, v68
  v_mul_f32 v65, 0xbfb8aa3b, v64
  v_exp_f32 v65, v65
  s_nop 0
  v_add_f32 v65, 1.0, v65
  v_rcp_f32 v65, v65
  s_nop 0
  v_mul_f32 v65, v65, v64
  v_cvt_pk_bf16_f32 v65, v65, v65
  v_and_b32 v65, 0xffff0000, v65
  v_mul_f32 v65, v65, v68
  v_cvt_pk_bf16_f32 v65, v65, v65
  v_and_b32 v65, 0xffff0000, v65
  v_lshlrev_b32 v201, 16, v201
  v_add_f32 v65, v65, v201
  v_cvt_pk_bf16_f32 v65, v65, v65
  s_mov_b32 exec_lo, 0xff00ff
  s_mov_b32 exec_hi, 0xff00ff
  buffer_store_short v65, v200, s[36:39], 0 offen
  s_cmp_lg_u32 s31, 0
  s_cbranch_scc1 L_end
  s_mov_b64 exec, 1
  v_mov_b32 v64, 0
  buffer_store_dword v3, v64, s[32:35], 0 offen
  s_branch L_end
L_A:
  s_getpc_b64 s[50:51]
L_pc2:
  s_sub_u32 s50, s50, L_pc2-recurrent_scan__compressed_kv_cla__geglu_ffn__decode_kernel
  s_subb_u32 s51, s51, 0
  s_lshr_b32 s52, s31, 3
  s_mul_i32 s52, s52, 4
  s_add_u32 s52, s52, s3
  s_min_u32 s52, s52, 21
  s_lshl_b32 s52, s52, 10
  v_lshlrev_b32 v5, 4, v0
  v_add_u32 v4, s52, v5
  global_load_dwordx4 v[250:253], v4, s[50:51]
  s_and_b32 s60, s31, 1
  s_lshr_b32 s61, s31, 1
  s_lshl_b32 s58, s60, 23
  s_lshl_b32 s62, s61, 17
  s_add_u32 s58, s58, s62
  s_lshl_b32 s62, s3, 9
  s_add_u32 s58, s58, s62
  s_lshl_b32 s59, s3, 15
  s_add_u32 s59, s59, 32768
  v_lshlrev_b32 v13, 1, v12
  v_xor_b32 v11, v11, v13
  v_lshlrev_b32 v11, 4, v11
  v_lshl_add_u32 v11, v12, 11, v11
  s_mov_b32 s42, 16777216
  s_waitcnt lgkmcnt(0)
  s_mov_b32 s40, s6
  s_mov_b32 s41, s7
  v_xor_b32 v13, 0, v11
  s_add_u32 s62, s58, 0
  s_add_u32 m0, s59, 0
  s_nop 0
  buffer_load_dwordx4 v13, s[40:43], s62 offen nt lds
  s_load_dword s30, s[28:29], 0
  s_mov_b32 s32, s28
  s_mov_b32 s33, s29
  s_waitcnt vmcnt(0)
  v_xor_b32 v13, 64, v11
  s_add_u32 s62, s58, 4096
  s_add_u32 m0, s59, 1024
  s_nop 0
  buffer_load_dwordx4 v13, s[40:43], s62 offen nt lds
  s_waitcnt vmcnt(0)
  v_xor_b32 v13, 128, v11
  s_add_u32 s62, s58, 8192
  s_add_u32 m0, s59, 2048
  s_nop 0
  buffer_load_dwordx4 v13, s[40:43], s62 offen nt lds
  s_waitcnt vmcnt(0)
  v_xor_b32 v13, 192, v11
  s_add_u32 s62, s58, 12288
  s_add_u32 m0, s59, 3072
  s_nop 0
  buffer_load_dwordx4 v13, s[40:43], s62 offen nt lds
  v_xor_b32 v13, 16, v11
  s_add_u32 s62, s58, 16384
  s_add_u32 m0, s59, 4096
  s_nop 0
  buffer_load_dwordx4 v13, s[40:43], s62 offen nt lds
  v_xor_b32 v13, 80, v11
  s_add_u32 s62, s58, 20480
  s_add_u32 m0, s59, 5120
  s_nop 0
  buffer_load_dwordx4 v13, s[40:43], s62 offen nt lds
  v_xor_b32 v13, 144, v11
  s_add_u32 s62, s58, 24576
  s_add_u32 m0, s59, 6144
  s_nop 0
  buffer_load_dwordx4 v13, s[40:43], s62 offen nt lds
  v_xor_b32 v13, 208, v11
  s_add_u32 s62, s58, 28672
  s_add_u32 m0, s59, 7168
  s_nop 0
  buffer_load_dwordx4 v13, s[40:43], s62 offen nt lds
  v_xor_b32 v13, 0, v11
  s_add_u32 s62, s58, 32768
  s_add_u32 m0, s59, 8192
  s_nop 0
  buffer_load_dwordx4 v13, s[40:43], s62 offen nt lds
  v_xor_b32 v13, 64, v11
  s_add_u32 s62, s58, 36864
  s_add_u32 m0, s59, 9216
  s_nop 0
  buffer_load_dwordx4 v13, s[40:43], s62 offen nt lds
  v_xor_b32 v13, 128, v11
  s_add_u32 s62, s58, 40960
  s_add_u32 m0, s59, 10240
  s_nop 0
  buffer_load_dwordx4 v13, s[40:43], s62 offen nt lds
  v_xor_b32 v13, 192, v11
  s_add_u32 s62, s58, 45056
  s_add_u32 m0, s59, 11264
  s_nop 0
  buffer_load_dwordx4 v13, s[40:43], s62 offen nt lds
  v_xor_b32 v13, 16, v11
  s_add_u32 s62, s58, 49152
  s_add_u32 m0, s59, 12288
  s_nop 0
  buffer_load_dwordx4 v13, s[40:43], s62 offen nt lds
  v_xor_b32 v13, 80, v11
  s_add_u32 s62, s58, 53248
  s_add_u32 m0, s59, 13312
  s_nop 0
  buffer_load_dwordx4 v13, s[40:43], s62 offen nt lds
  v_xor_b32 v13, 144, v11
  s_add_u32 s62, s58, 57344
  s_add_u32 m0, s59, 14336
  s_nop 0
  buffer_load_dwordx4 v13, s[40:43], s62 offen nt lds
  v_xor_b32 v13, 208, v11
  s_add_u32 s62, s58, 61440
  s_add_u32 m0, s59, 15360
  s_nop 0
  buffer_load_dwordx4 v13, s[40:43], s62 offen nt lds
  s_mov_b32 s44, 0x07060500
  s_mov_b32 s45, 0x07060501
  s_mov_b32 s46, 0x07060502
  s_mov_b32 s47, 0x07060503
  s_mov_b32 s48, 0x0c0c0400
  s_mov_b32 s49, 0x04000c0c
  v_and_b32 v40, 7, v0
  v_lshlrev_b32 v40, 1, v40
  v_bfe_u32 v41, v0, 3, 1
  v_or_b32 v40, v40, v41
  v_lshlrev_b32 v41, 1, v2
  v_xor_b32 v40, v40, v41
  v_lshlrev_b32 v40, 4, v40
  v_lshl_add_u32 v40, v1, 9, v40
  v_add_u32 v44, s59, v40
  v_xor_b32 v45, 16, v44
  v_xor_b32 v46, 128, v44
  v_xor_b32 v47, 144, v44
  v_lshrrev_b32 v40, 2, v1
  v_lshl_add_u32 v40, v2, 2, v40
  v_and_b32 v41, 7, v40
  v_lshlrev_b32 v41, 1, v41
  v_lshrrev_b32 v42, 3, v40
  v_or_b32 v41, v41, v42
  v_bfe_u32 v42, v0, 1, 1
  v_xor_b32 v41, v41, v42
  v_lshlrev_b32 v40, 9, v40
  v_lshl_add_u32 v40, v41, 4, v40
  v_lshl_add_u32 v40, v14, 3, v40
  v_add_u32 v16, s59, v40
  v_xor_b32 v17, 32, v16
  v_xor_b32 v18, 64, v16
  v_xor_b32 v19, 96, v16
  v_xor_b32 v20, 128, v16
  v_xor_b32 v21, 160, v16
  v_xor_b32 v22, 192, v16
  v_xor_b32 v23, 224, v16
  s_waitcnt lgkmcnt(0)
  s_add_u32 s30, s30, 0x01010101
  v_mov_b32 v3, s30
  v_and_b32 v39, 3, v0
  v_lshlrev_b32 v39, 3, v39
  v_lshrrev_b32 v39, v39, v3
  v_bfe_u32 v24, v39, 0, 1
  v_bfe_u32 v13, v39, 1, 1
  v_lshl_or_b32 v24, v13, 16, v24
  v_xor_b32 v28, 0x10001, v24
  v_bfe_u32 v25, v39, 2, 1
  v_bfe_u32 v13, v39, 3, 1
  v_lshl_or_b32 v25, v13, 16, v25
  v_xor_b32 v29, 0x10001, v25
  v_bfe_u32 v26, v39, 4, 1
  v_bfe_u32 v13, v39, 5, 1
  v_lshl_or_b32 v26, v13, 16, v26
  v_xor_b32 v30, 0x10001, v26
  v_bfe_u32 v27, v39, 6, 1
  v_bfe_u32 v13, v39, 7, 1
  v_lshl_or_b32 v27, v13, 16, v27
  v_xor_b32 v31, 0x10001, v27
  v_lshlrev_b32 v39, 3, v2
  v_lshrrev_b32 v39, v39, v3
  v_bfe_u32 v32, v39, 0, 1
  v_bfe_u32 v13, v39, 1, 1
  v_lshl_or_b32 v32, v13, 16, v32
  v_bfe_u32 v33, v39, 2, 1
  v_bfe_u32 v13, v39, 3, 1
  v_lshl_or_b32 v33, v13, 16, v33
  v_bfe_u32 v34, v39, 4, 1
  v_bfe_u32 v13, v39, 5, 1
  v_lshl_or_b32 v34, v13, 16, v34
  v_bfe_u32 v35, v39, 6, 1
  v_bfe_u32 v13, v39, 7, 1
  v_lshl_or_b32 v35, v13, 16, v35
  v_xor_b32 v37, v2, v1
  v_lshlrev_b32 v37, 4, v37
  v_mul_u32_u24 v38, 16640, v2
  v_add_u32 v38, v38, v37
  v_lshl_add_u32 v48, v1, 8, v37
  v_add_u32 v48, s59, v48
  v_xor_b32 v49, 64, v48
  v_xor_b32 v50, 128, v48
  v_xor_b32 v51, 192, v48
  s_lshl_b32 s70, s60, 8
  s_mul_i32 s63, s3, 532480
  s_add_u32 s70, s70, s63
  s_add_u32 s70, s70, 2100736
  v_xor_b32 v13, 0, v11
  s_add_u32 s62, s58, 65536
  s_add_u32 m0, s59, 16384
  s_nop 0
  buffer_load_dwordx4 v13, s[40:43], s62 offen nt lds
  v_xor_b32 v13, 64, v11
  s_add_u32 s62, s58, 69632
  s_add_u32 m0, s59, 17408
  s_nop 0
  buffer_load_dwordx4 v13, s[40:43], s62 offen nt lds
  v_xor_b32 v13, 128, v11
  s_add_u32 s62, s58, 73728
  s_add_u32 m0, s59, 18432
  s_nop 0
  buffer_load_dwordx4 v13, s[40:43], s62 offen nt lds
  v_xor_b32 v13, 192, v11
  s_add_u32 s62, s58, 77824
  s_add_u32 m0, s59, 19456
  s_nop 0
  buffer_load_dwordx4 v13, s[40:43], s62 offen nt lds
  v_xor_b32 v13, 16, v11
  s_add_u32 s62, s58, 81920
  s_add_u32 m0, s59, 20480
  s_nop 0
  buffer_load_dwordx4 v13, s[40:43], s62 offen nt lds
  v_xor_b32 v13, 80, v11
  s_add_u32 s62, s58, 86016
  s_add_u32 m0, s59, 21504
  s_nop 0
  buffer_load_dwordx4 v13, s[40:43], s62 offen nt lds
  v_xor_b32 v13, 144, v11
  s_add_u32 s62, s58, 90112
  s_add_u32 m0, s59, 22528
  s_nop 0
  buffer_load_dwordx4 v13, s[40:43], s62 offen nt lds
  v_xor_b32 v13, 208, v11
  s_add_u32 s62, s58, 94208
  s_add_u32 m0, s59, 23552
  s_nop 0
  buffer_load_dwordx4 v13, s[40:43], s62 offen nt lds
  s_waitcnt vmcnt(16)
  ds_read_b128 a[0:3], v44 offset:0
  ds_read_b128 a[4:7], v45 offset:0
  ds_read_b128 a[8:11], v46 offset:0
  ds_read_b128 a[12:15], v47 offset:0
  ds_read_b128 a[16:19], v44 offset:256
  ds_read_b128 a[20:23], v45 offset:256
  ds_read_b128 a[24:27], v46 offset:256
  ds_read_b128 a[28:31], v47 offset:256
  ds_read_b64_tr_b16 a[128:129], v16 offset:0
  ds_read_b64_tr_b16 a[136:137], v17 offset:0
  ds_read_b64_tr_b16 a[144:145], v18 offset:0
  ds_read_b64_tr_b16 a[152:153], v19 offset:0
  ds_read_b64_tr_b16 a[160:161], v20 offset:0
  ds_read_b64_tr_b16 a[168:169], v21 offset:0
  ds_read_b64_tr_b16 a[176:177], v22 offset:0
  ds_read_b64_tr_b16 a[184:185], v23 offset:0
  ds_read_b64_tr_b16 a[192:193], v16 offset:256
  ds_read_b64_tr_b16 a[200:201], v17 offset:256
  ds_read_b64_tr_b16 a[208:209], v18 offset:256
  ds_read_b64_tr_b16 a[216:217], v19 offset:256
  ds_read_b64_tr_b16 a[224:225], v20 offset:256
  ds_read_b64_tr_b16 a[232:233], v21 offset:256
  ds_read_b64_tr_b16 a[240:241], v22 offset:256
  ds_read_b64_tr_b16 a[248:249], v23 offset:256
  v_xor_b32 v13, 0, v11
  s_add_u32 s62, s58, 98304
  s_add_u32 m0, s59, 24576
  s_nop 0
  buffer_load_dwordx4 v13, s[40:43], s62 offen nt lds
  v_xor_b32 v13, 64, v11
  s_add_u32 s62, s58, 102400
  s_add_u32 m0, s59, 25600
  s_nop 0
  buffer_load_dwordx4 v13, s[40:43], s62 offen nt lds
  v_xor_b32 v13, 128, v11
  s_add_u32 s62, s58, 106496
  s_add_u32 m0, s59, 26624
  s_nop 0
  buffer_load_dwordx4 v13, s[40:43], s62 offen nt lds
  v_xor_b32 v13, 192, v11
  s_add_u32 s62, s58, 110592
  s_add_u32 m0, s59, 27648
  s_nop 0
  buffer_load_dwordx4 v13, s[40:43], s62 offen nt lds
  v_xor_b32 v13, 16, v11
  s_add_u32 s62, s58, 114688
  s_add_u32 m0, s59, 28672
  s_nop 0
  buffer_load_dwordx4 v13, s[40:43], s62 offen nt lds
  v_xor_b32 v13, 80, v11
  s_add_u32 s62, s58, 118784
  s_add_u32 m0, s59, 29696
  s_nop 0
  buffer_load_dwordx4 v13, s[40:43], s62 offen nt lds
  v_xor_b32 v13, 144, v11
  s_add_u32 s62, s58, 122880
  s_add_u32 m0, s59, 30720
  s_nop 0
  buffer_load_dwordx4 v13, s[40:43], s62 offen nt lds
  v_xor_b32 v13, 208, v11
  s_add_u32 s62, s58, 126976
  s_add_u32 m0, s59, 31744
  s_nop 0
  buffer_load_dwordx4 v13, s[40:43], s62 offen nt lds
  s_waitcnt vmcnt(16)
  ds_read_b128 a[32:35], v44 offset:8192
  ds_read_b128 a[36:39], v45 offset:8192
  ds_read_b128 a[40:43], v46 offset:8192
  ds_read_b128 a[44:47], v47 offset:8192
  ds_read_b128 a[48:51], v44 offset:8448
  ds_read_b128 a[52:55], v45 offset:8448
  ds_read_b128 a[56:59], v46 offset:8448
  ds_read_b128 a[60:63], v47 offset:8448
  ds_read_b64_tr_b16 a[130:131], v16 offset:8192
  ds_read_b64_tr_b16 a[138:139], v17 offset:8192
  ds_read_b64_tr_b16 a[146:147], v18 offset:8192
  ds_read_b64_tr_b16 a[154:155], v19 offset:8192
  ds_read_b64_tr_b16 a[162:163], v20 offset:8192
  ds_read_b64_tr_b16 a[170:171], v21 offset:8192
  ds_read_b64_tr_b16 a[178:179], v22 offset:8192
  ds_read_b64_tr_b16 a[186:187], v23 offset:8192
  ds_read_b64_tr_b16 a[194:195], v16 offset:8448
  ds_read_b64_tr_b16 a[202:203], v17 offset:8448
  ds_read_b64_tr_b16 a[210:211], v18 offset:8448
  ds_read_b64_tr_b16 a[218:219], v19 offset:8448
  ds_read_b64_tr_b16 a[226:227], v20 offset:8448
  ds_read_b64_tr_b16 a[234:235], v21 offset:8448
  ds_read_b64_tr_b16 a[242:243], v22 offset:8448
  ds_read_b64_tr_b16 a[250:251], v23 offset:8448
  s_waitcnt lgkmcnt(0)
  s_barrier
  v_xor_b32 v13, 0, v38
  s_add_u32 s62, s70, 0
  s_add_u32 m0, s59, 0
  s_nop 0
  buffer_load_dwordx4 v13, s[32:35], s62 offen sc1 lds
  v_xor_b32 v13, 64, v38
  s_add_u32 s62, s70, 66560
  s_add_u32 m0, s59, 1024
  s_nop 0
  buffer_load_dwordx4 v13, s[32:35], s62 offen sc1 lds
  v_xor_b32 v13, 128, v38
  s_add_u32 s62, s70, 133120
  s_add_u32 m0, s59, 2048
  s_nop 0
  buffer_load_dwordx4 v13, s[32:35], s62 offen sc1 lds
  v_xor_b32 v13, 192, v38
  s_add_u32 s62, s70, 199680
  s_add_u32 m0, s59, 3072
  s_nop 0
  buffer_load_dwordx4 v13, s[32:35], s62 offen sc1 lds
  v_xor_b32 v13, 0, v38
  s_add_u32 s62, s70, 266240
  s_add_u32 m0, s59, 4096
  s_nop 0
  buffer_load_dwordx4 v13, s[32:35], s62 offen sc1 lds
  v_xor_b32 v13, 64, v38
  s_add_u32 s62, s70, 332800
  s_add_u32 m0, s59, 5120
  s_nop 0
  buffer_load_dwordx4 v13, s[32:35], s62 offen sc1 lds
  v_xor_b32 v13, 128, v38
  s_add_u32 s62, s70, 399360
  s_add_u32 m0, s59, 6144
  s_nop 0
  buffer_load_dwordx4 v13, s[32:35], s62 offen sc1 lds
  v_xor_b32 v13, 192, v38
  s_add_u32 s62, s70, 465920
  s_add_u32 m0, s59, 7168
  s_nop 0
  buffer_load_dwordx4 v13, s[32:35], s62 offen sc1 lds
  v_lshlrev_b32 v40, 4, v0
  v_add_u32 v41, s59, v40
  s_lshl_b32 s64, s3, 10
  s_add_u32 s64, s64, 32768
  v_add_u32 v42, s64, v40
  v_add_u32 v43, 0x10000, v42
  v_lshlrev_b32 v56, 5, v0
  s_lshl_b32 s64, s3, 3
  v_add_u32 v57, s64, v56
  v_lshlrev_b32 v58, 4, v1
  s_lshl_b32 s64, s3, 2
  v_add_u32 v59, s64, v58
  v_mov_b32 v60, 0x3f803f80
  v_mov_b32 v61, v60
  v_mov_b32 v62, v60
  v_mov_b32 v63, v60
  v_mul_u32_u24 v36, 132096, v2
  v_lshl_add_u32 v36, v1, 4, v36
  s_mul_i32 s64, s3, 1056768
  s_lshl_b32 s63, s31, 8
  s_add_u32 s64, s64, s63
  s_add_u32 s64, s64, 8388608
  s_mul_i32 s66, s31, 16640
  s_add_u32 s66, s66, 2101248
  s_mov_b32 s65, 0xfffefffe
  s_mov_b32 s67, 0x07060302
  s_cmp_eq_u32 s3, 3
  s_cselect_b32 s68, 0xffff, 0
  s_lshr_b32 s62, s31, 5
  s_lshl_b32 s63, s62, 6
  v_mov_b32 v52, s63
  v_mov_b32 v53, 1
  s_add_u32 s73, s63, 2101504
  v_mul_u32_u24 v54, 16640, v0
  s_mov_b32 s74, 0
  s_waitcnt vmcnt(16)
  ds_read_b128 a[64:67], v44 offset:16384
  ds_read_b128 a[68:71], v45 offset:16384
  ds_read_b128 a[72:75], v46 offset:16384
  ds_read_b128 a[76:79], v47 offset:16384
  ds_read_b128 a[80:83], v44 offset:16640
  ds_read_b128 a[84:87], v45 offset:16640
  ds_read_b128 a[88:91], v46 offset:16640
  ds_read_b128 a[92:95], v47 offset:16640
  ds_read_b64_tr_b16 a[132:133], v16 offset:16384
  ds_read_b64_tr_b16 a[140:141], v17 offset:16384
  ds_read_b64_tr_b16 a[148:149], v18 offset:16384
  ds_read_b64_tr_b16 a[156:157], v19 offset:16384
  ds_read_b64_tr_b16 a[164:165], v20 offset:16384
  ds_read_b64_tr_b16 a[172:173], v21 offset:16384
  ds_read_b64_tr_b16 a[180:181], v22 offset:16384
  ds_read_b64_tr_b16 a[188:189], v23 offset:16384
  ds_read_b64_tr_b16 a[196:197], v16 offset:16640
  ds_read_b64_tr_b16 a[204:205], v17 offset:16640
  ds_read_b64_tr_b16 a[212:213], v18 offset:16640
  ds_read_b64_tr_b16 a[220:221], v19 offset:16640
  ds_read_b64_tr_b16 a[228:229], v20 offset:16640
  ds_read_b64_tr_b16 a[236:237], v21 offset:16640
  ds_read_b64_tr_b16 a[244:245], v22 offset:16640
  ds_read_b64_tr_b16 a[252:253], v23 offset:16640
  s_waitcnt vmcnt(8)
  ds_read_b128 a[96:99], v44 offset:24576
  ds_read_b128 a[100:103], v45 offset:24576
  ds_read_b128 a[104:107], v46 offset:24576
  ds_read_b128 a[108:111], v47 offset:24576
  ds_read_b128 a[112:115], v44 offset:24832
  ds_read_b128 a[116:119], v45 offset:24832
  ds_read_b128 a[120:123], v46 offset:24832
  ds_read_b128 a[124:127], v47 offset:24832
  ds_read_b64_tr_b16 a[134:135], v16 offset:24576
  ds_read_b64_tr_b16 a[142:143], v17 offset:24576
  ds_read_b64_tr_b16 a[150:151], v18 offset:24576
  ds_read_b64_tr_b16 a[158:159], v19 offset:24576
  ds_read_b64_tr_b16 a[166:167], v20 offset:24576
  ds_read_b64_tr_b16 a[174:175], v21 offset:24576
  ds_read_b64_tr_b16 a[182:183], v22 offset:24576
  ds_read_b64_tr_b16 a[190:191], v23 offset:24576
  ds_read_b64_tr_b16 a[198:199], v16 offset:24832
  ds_read_b64_tr_b16 a[206:207], v17 offset:24832
  ds_read_b64_tr_b16 a[214:215], v18 offset:24832
  ds_read_b64_tr_b16 a[222:223], v19 offset:24832
  ds_read_b64_tr_b16 a[230:231], v20 offset:24832
  ds_read_b64_tr_b16 a[238:239], v21 offset:24832
  ds_read_b64_tr_b16 a[246:247], v22 offset:24832
  ds_read_b64_tr_b16 a[254:255], v23 offset:24832
  s_mov_b32 s75, 0
  s_mov_b32 s96, 400000
  s_waitcnt lgkmcnt(0)
L_qk:
  s_waitcnt vmcnt(4)
  ds_read_b128 v[64:67], v48
  ds_read_b128 v[68:71], v49
  ds_read_b128 v[72:75], v50
  ds_read_b128 v[76:79], v51
  s_waitcnt lgkmcnt(3)
  v_mfma_f32_16x16x32_bf16 v[96:99], a[0:3], v[64:67], 0
  v_xor_b32 v55, v64, v32
  v_mfma_f32_16x16x32_bf16 v[100:103], a[32:35], v[64:67], 0
  v_bitop3_b32 v55, v65, v33, v55 bitop3:0xbe
  v_mfma_f32_16x16x32_bf16 v[104:107], a[64:67], v[64:67], 0
  v_bitop3_b32 v55, v66, v34, v55 bitop3:0xbe
  v_mfma_f32_16x16x32_bf16 v[108:111], a[96:99], v[64:67], 0
  v_bitop3_b32 v55, v67, v35, v55 bitop3:0xbe
  s_waitcnt vmcnt(0)
  ds_read_b128 v[80:83], v48 offset:4096
  ds_read_b128 v[84:87], v49 offset:4096
  ds_read_b128 v[88:91], v50 offset:4096
  ds_read_b128 v[92:95], v51 offset:4096
  s_waitcnt lgkmcnt(6)
  v_mfma_f32_16x16x32_bf16 v[96:99], a[4:7], v[68:71], v[96:99]
  v_bitop3_b32 v55, v68, v32, v55 bitop3:0xbe
  v_mfma_f32_16x16x32_bf16 v[100:103], a[36:39], v[68:71], v[100:103]
  v_bitop3_b32 v55, v69, v33, v55 bitop3:0xbe
  v_mfma_f32_16x16x32_bf16 v[104:107], a[68:71], v[68:71], v[104:107]
  v_bitop3_b32 v55, v70, v34, v55 bitop3:0xbe
  v_mfma_f32_16x16x32_bf16 v[108:111], a[100:103], v[68:71], v[108:111]
  v_bitop3_b32 v55, v71, v35, v55 bitop3:0xbe
  s_waitcnt lgkmcnt(5)
  v_mfma_f32_16x16x32_bf16 v[96:99], a[8:11], v[72:75], v[96:99]
  v_bitop3_b32 v55, v72, v32, v55 bitop3:0xbe
  v_mfma_f32_16x16x32_bf16 v[100:103], a[40:43], v[72:75], v[100:103]
  v_bitop3_b32 v55, v73, v33, v55 bitop3:0xbe
  v_mfma_f32_16x16x32_bf16 v[104:107], a[72:75], v[72:75], v[104:107]
  v_bitop3_b32 v55, v74, v34, v55 bitop3:0xbe
  v_mfma_f32_16x16x32_bf16 v[108:111], a[104:107], v[72:75], v[108:111]
  v_bitop3_b32 v55, v75, v35, v55 bitop3:0xbe
  s_waitcnt lgkmcnt(4)
  v_mfma_f32_16x16x32_bf16 v[96:99], a[12:15], v[76:79], v[96:99]
  v_bitop3_b32 v55, v76, v32, v55 bitop3:0xbe
  v_mfma_f32_16x16x32_bf16 v[100:103], a[44:47], v[76:79], v[100:103]
  v_bitop3_b32 v55, v77, v33, v55 bitop3:0xbe
  v_mfma_f32_16x16x32_bf16 v[104:107], a[76:79], v[76:79], v[104:107]
  v_bitop3_b32 v55, v78, v34, v55 bitop3:0xbe
  v_mfma_f32_16x16x32_bf16 v[108:111], a[108:111], v[76:79], v[108:111]
  v_bitop3_b32 v55, v79, v35, v55 bitop3:0xbe
  s_waitcnt lgkmcnt(3)
  v_mfma_f32_16x16x32_bf16 v[96:99], a[16:19], v[80:83], v[96:99]
  v_bitop3_b32 v55, v80, v32, v55 bitop3:0xbe
  v_mfma_f32_16x16x32_bf16 v[100:103], a[48:51], v[80:83], v[100:103]
  v_bitop3_b32 v55, v81, v33, v55 bitop3:0xbe
  v_mfma_f32_16x16x32_bf16 v[104:107], a[80:83], v[80:83], v[104:107]
  v_bitop3_b32 v55, v82, v34, v55 bitop3:0xbe
  v_mfma_f32_16x16x32_bf16 v[108:111], a[112:115], v[80:83], v[108:111]
  v_bitop3_b32 v55, v83, v35, v55 bitop3:0xbe
  s_waitcnt lgkmcnt(2)
  v_mfma_f32_16x16x32_bf16 v[96:99], a[20:23], v[84:87], v[96:99]
  v_bitop3_b32 v55, v84, v32, v55 bitop3:0xbe
  v_mfma_f32_16x16x32_bf16 v[100:103], a[52:55], v[84:87], v[100:103]
  v_bitop3_b32 v55, v85, v33, v55 bitop3:0xbe
  v_mfma_f32_16x16x32_bf16 v[104:107], a[84:87], v[84:87], v[104:107]
  v_bitop3_b32 v55, v86, v34, v55 bitop3:0xbe
  v_mfma_f32_16x16x32_bf16 v[108:111], a[116:119], v[84:87], v[108:111]
  v_bitop3_b32 v55, v87, v35, v55 bitop3:0xbe
  s_waitcnt lgkmcnt(1)
  v_mfma_f32_16x16x32_bf16 v[96:99], a[24:27], v[88:91], v[96:99]
  v_bitop3_b32 v55, v88, v32, v55 bitop3:0xbe
  v_mfma_f32_16x16x32_bf16 v[100:103], a[56:59], v[88:91], v[100:103]
  v_bitop3_b32 v55, v89, v33, v55 bitop3:0xbe
  v_mfma_f32_16x16x32_bf16 v[104:107], a[88:91], v[88:91], v[104:107]
  v_bitop3_b32 v55, v90, v34, v55 bitop3:0xbe
  v_mfma_f32_16x16x32_bf16 v[108:111], a[120:123], v[88:91], v[108:111]
  v_bitop3_b32 v55, v91, v35, v55 bitop3:0xbe
  s_waitcnt lgkmcnt(0)
  v_mfma_f32_16x16x32_bf16 v[96:99], a[28:31], v[92:95], v[96:99]
  v_bitop3_b32 v55, v92, v32, v55 bitop3:0xbe
  v_mfma_f32_16x16x32_bf16 v[100:103], a[60:63], v[92:95], v[100:103]
  v_bitop3_b32 v55, v93, v33, v55 bitop3:0xbe
  v_mfma_f32_16x16x32_bf16 v[104:107], a[92:95], v[92:95], v[104:107]
  v_bitop3_b32 v55, v94, v34, v55 bitop3:0xbe
  v_mfma_f32_16x16x32_bf16 v[108:111], a[124:127], v[92:95], v[108:111]
  v_bitop3_b32 v55, v95, v35, v55 bitop3:0xbe
  v_and_b32 v55, 0x10001, v55
  v_cmp_ne_u32 vcc, 0, v55
  s_cbranch_vccz L_qk2
  s_nop 7
  v_xor_b32 v13, 0, v38
  s_add_u32 s62, s70, 0
  s_add_u32 m0, s59, 0
  s_nop 0
  buffer_load_dwordx4 v13, s[32:35], s62 offen sc1 lds
  v_xor_b32 v13, 64, v38
  s_add_u32 s62, s70, 66560
  s_add_u32 m0, s59, 1024
  s_nop 0
  buffer_load_dwordx4 v13, s[32:35], s62 offen sc1 lds
  v_xor_b32 v13, 128, v38
  s_add_u32 s62, s70, 133120
  s_add_u32 m0, s59, 2048
  s_nop 0
  buffer_load_dwordx4 v13, s[32:35], s62 offen sc1 lds
  v_xor_b32 v13, 192, v38
  s_add_u32 s62, s70, 199680
  s_add_u32 m0, s59, 3072
  s_nop 0
  buffer_load_dwordx4 v13, s[32:35], s62 offen sc1 lds
  v_xor_b32 v13, 0, v38
  s_add_u32 s62, s70, 266240
  s_add_u32 m0, s59, 4096
  s_nop 0
  buffer_load_dwordx4 v13, s[32:35], s62 offen sc1 lds
  v_xor_b32 v13, 64, v38
  s_add_u32 s62, s70, 332800
  s_add_u32 m0, s59, 5120
  s_nop 0
  buffer_load_dwordx4 v13, s[32:35], s62 offen sc1 lds
  v_xor_b32 v13, 128, v38
  s_add_u32 s62, s70, 399360
  s_add_u32 m0, s59, 6144
  s_nop 0
  buffer_load_dwordx4 v13, s[32:35], s62 offen sc1 lds
  v_xor_b32 v13, 192, v38
  s_add_u32 s62, s70, 465920
  s_add_u32 m0, s59, 7168
  s_nop 0
  buffer_load_dwordx4 v13, s[32:35], s62 offen sc1 lds
  s_sub_u32 s96, s96, 1
  s_cbranch_scc1 L_end
  s_branch L_qk
L_qk2:
  s_nop 4
  s_cmp_lg_u32 s3, 2
  s_cbranch_scc1 L_arr
  s_mov_b64 exec, 1
  global_atomic_add v53, v52, v53, s[26:27] sc0 sc1
  s_mov_b64 exec, -1
L_arr:
  ds_write_b128 v41, v[96:99] offset:0
  ds_write_b128 v41, v[100:103] offset:1024
  ds_write_b128 v41, v[104:107] offset:2048
  ds_write_b128 v41, v[108:111] offset:3072
  s_waitcnt lgkmcnt(0)
  s_barrier
  ds_read_b128 v[64:67], v42
  ds_read_b128 v[68:71], v42 offset:32768
  ds_read_b128 v[72:75], v43
  ds_read_b128 v[76:79], v43 offset:32768
  s_waitcnt lgkmcnt(2)
  v_add_f32 v64, v64, v68
  v_add_f32 v65, v65, v69
  v_add_f32 v66, v66, v70
  v_add_f32 v67, v67, v71
  s_waitcnt lgkmcnt(0)
  v_add_f32 v72, v72, v76
  v_add_f32 v73, v73, v77
  v_add_f32 v74, v74, v78
  v_add_f32 v75, v75, v79
  v_add_f32 v64, v64, v72
  v_add_f32 v65, v65, v73
  v_add_f32 v66, v66, v74
  v_add_f32 v67, v67, v75
  v_mul_f32 v64, 0x3fb8aa3b, v64
  v_mul_f32 v65, 0x3fb8aa3b, v65
  v_mul_f32 v66, 0x3fb8aa3b, v66
  v_mul_f32 v67, 0x3fb8aa3b, v67
  v_max3_f32 v68, v64, v65, v66
  v_max_f32 v68, v68, v67
  v_mov_b32 v69, v68
  s_nop 1
  v_permlane16_swap_b32 v69, v68
  v_max_f32 v68, v68, v69
  v_mov_b32 v69, v68
  s_nop 1
  v_permlane32_swap_b32 v69, v68
  v_max_f32 v68, v68, v69
  v_ceil_f32 v68, v68
  v_sub_f32 v64, v64, v68
  v_sub_f32 v65, v65, v68
  v_sub_f32 v66, v66, v68
  v_sub_f32 v67, v67, v68
  v_exp_f32 v64, v64
  v_exp_f32 v65, v65
  v_exp_f32 v66, v66
  v_exp_f32 v67, v67
  ds_write_b32 v59, v68 offset:3840
  v_cvt_pk_bf16_f32 v64, v64, v65
  v_cvt_pk_bf16_f32 v65, v66, v67
  ds_write_b64 v57, v[64:65] offset:1792
  s_waitcnt lgkmcnt(0)
  s_barrier
  s_cmp_lg_u32 s3, 2
  s_cbranch_scc1 L_res
  s_waitcnt vmcnt(0)
L_res2:
  v_readfirstlane_b32 s74, v53
L_res:
  ds_read_b128 v[72:75], v58 offset:3840
  ds_read_b128 v[64:67], v56 offset:1792
  ds_read_b128 v[68:71], v56 offset:1808
  s_waitcnt lgkmcnt(2)
  v_max3_f32 v76, v72, v73, v74
  v_max_f32 v76, v76, v75
  v_sub_f32 v72, v76, v72
  v_min_f32 v72, 0x437f0000, v72
  v_cvt_u32_f32 v72, v72
  v_mul_u32_u24 v72, 0x800080, v72
  v_sub_f32 v73, v76, v73
  v_min_f32 v73, 0x437f0000, v73
  v_cvt_u32_f32 v73, v73
  v_mul_u32_u24 v73, 0x800080, v73
  v_sub_f32 v74, v76, v74
  v_min_f32 v74, 0x437f0000, v74
  v_cvt_u32_f32 v74, v74
  v_mul_u32_u24 v74, 0x800080, v74
  v_sub_f32 v75, v76, v75
  v_min_f32 v75, 0x437f0000, v75
  v_cvt_u32_f32 v75, v75
  v_mul_u32_u24 v75, 0x800080, v75
  s_waitcnt lgkmcnt(0)
  v_pk_sub_u16 v64, v64, v72 clamp
  v_pk_sub_u16 v65, v65, v72 clamp
  v_pk_sub_u16 v66, v66, v73 clamp
  v_pk_sub_u16 v67, v67, v73 clamp
  v_pk_sub_u16 v68, v68, v74 clamp
  v_pk_sub_u16 v69, v69, v74 clamp
  v_pk_sub_u16 v70, v70, v75 clamp
  v_pk_sub_u16 v71, v71, v75 clamp
  v_mfma_f32_16x16x32_bf16 v[80:83], v[60:63], v[64:67], 0
  s_nop 0
  v_mfma_f32_16x16x32_bf16 v[80:83], v[60:63], v[68:71], v[80:83]
  v_mfma_f32_16x16x32_bf16 v[128:131], v[64:67], a[128:131], 0
  v_mfma_f32_16x16x32_bf16 v[128:131], v[68:71], a[132:135], v[128:131]
  v_mfma_f32_16x16x32_bf16 v[132:135], v[64:67], a[136:139], 0
  v_mfma_f32_16x16x32_bf16 v[132:135], v[68:71], a[140:143], v[132:135]
  v_mfma_f32_16x16x32_bf16 v[136:139], v[64:67], a[144:147], 0
  v_mfma_f32_16x16x32_bf16 v[136:139], v[68:71], a[148:151], v[136:139]
  v_mfma_f32_16x16x32_bf16 v[140:143], v[64:67], a[152:155], 0
  v_mfma_f32_16x16x32_bf16 v[140:143], v[68:71], a[156:159], v[140:143]
  v_mfma_f32_16x16x32_bf16 v[144:147], v[64:67], a[160:163], 0
  v_mfma_f32_16x16x32_bf16 v[144:147], v[68:71], a[164:167], v[144:147]
  v_mfma_f32_16x16x32_bf16 v[148:151], v[64:67], a[168:171], 0
  v_mfma_f32_16x16x32_bf16 v[148:151], v[68:71], a[172:175], v[148:151]
  v_mfma_f32_16x16x32_bf16 v[152:155], v[64:67], a[176:179], 0
  v_mfma_f32_16x16x32_bf16 v[152:155], v[68:71], a[180:183], v[152:155]
  v_mfma_f32_16x16x32_bf16 v[156:159], v[64:67], a[184:187], 0
  v_mfma_f32_16x16x32_bf16 v[156:159], v[68:71], a[188:191], v[156:159]
  v_mov_b32 v77, v80
  v_mov_b32 v78, v3
  v_mov_b32 v79, v3
  s_mov_b32 exec_lo, s68
  s_mov_b32 exec_hi, 0
  s_cbranch_execz L_st0
  buffer_store_dwordx4 v[76:79], v40, s[32:35], s66 offen sc1
L_st0:
  s_mov_b64 exec, -1
  v_mfma_f32_16x16x32_bf16 v[160:163], v[64:67], a[192:195], 0
  v_mfma_f32_16x16x32_bf16 v[160:163], v[68:71], a[196:199], v[160:163]
  v_mfma_f32_16x16x32_bf16 v[164:167], v[64:67], a[200:203], 0
  v_perm_b32 v96, v132, v128, s67
  v_pk_add_u16 v96, v96, v28
  v_and_or_b32 v96, v96, s65, v24
  v_perm_b32 v97, v140, v136, s67
  v_mfma_f32_16x16x32_bf16 v[164:167], v[68:71], a[204:207], v[164:167]
  v_pk_add_u16 v97, v97, v29
  v_and_or_b32 v97, v97, s65, v25
  v_perm_b32 v98, v148, v144, s67
  v_pk_add_u16 v98, v98, v30
  v_mfma_f32_16x16x32_bf16 v[168:171], v[64:67], a[208:211], 0
  v_and_or_b32 v98, v98, s65, v26
  v_perm_b32 v99, v156, v152, s67
  v_pk_add_u16 v99, v99, v31
  v_and_or_b32 v99, v99, s65, v27
  v_mfma_f32_16x16x32_bf16 v[168:171], v[68:71], a[212:215], v[168:171]
  s_add_u32 s63, s64, 0
  buffer_store_dwordx4 v[96:99], v36, s[32:35], s63 offen sc1
  v_perm_b32 v100, v133, v129, s67
  v_pk_add_u16 v100, v100, v28
  v_mfma_f32_16x16x32_bf16 v[172:175], v[64:67], a[216:219], 0
  v_and_or_b32 v100, v100, s65, v24
  v_perm_b32 v101, v141, v137, s67
  v_pk_add_u16 v101, v101, v29
  v_and_or_b32 v101, v101, s65, v25
  v_mfma_f32_16x16x32_bf16 v[172:175], v[68:71], a[220:223], v[172:175]
  v_perm_b32 v102, v149, v145, s67
  v_pk_add_u16 v102, v102, v30
  v_and_or_b32 v102, v102, s65, v26
  v_perm_b32 v103, v157, v153, s67
  v_mfma_f32_16x16x32_bf16 v[176:179], v[64:67], a[224:227], 0
  v_pk_add_u16 v103, v103, v31
  v_and_or_b32 v103, v103, s65, v27
  s_add_u32 s63, s64, 33024
  buffer_store_dwordx4 v[100:103], v36, s[32:35], s63 offen sc1
  v_mfma_f32_16x16x32_bf16 v[176:179], v[68:71], a[228:231], v[176:179]
  v_perm_b32 v104, v134, v130, s67
  v_pk_add_u16 v104, v104, v28
  v_and_or_b32 v104, v104, s65, v24
  v_perm_b32 v105, v142, v138, s67
  v_mfma_f32_16x16x32_bf16 v[180:183], v[64:67], a[232:235], 0
  v_pk_add_u16 v105, v105, v29
  v_and_or_b32 v105, v105, s65, v25
  v_perm_b32 v106, v150, v146, s67
  v_pk_add_u16 v106, v106, v30
  v_mfma_f32_16x16x32_bf16 v[180:183], v[68:71], a[236:239], v[180:183]
  v_and_or_b32 v106, v106, s65, v26
  v_perm_b32 v107, v158, v154, s67
  v_pk_add_u16 v107, v107, v31
  v_and_or_b32 v107, v107, s65, v27
  v_mfma_f32_16x16x32_bf16 v[184:187], v[64:67], a[240:243], 0
  s_add_u32 s63, s64, 66048
  buffer_store_dwordx4 v[104:107], v36, s[32:35], s63 offen sc1
  v_perm_b32 v108, v135, v131, s67
  v_pk_add_u16 v108, v108, v28
  v_mfma_f32_16x16x32_bf16 v[184:187], v[68:71], a[244:247], v[184:187]
  v_and_or_b32 v108, v108, s65, v24
  v_perm_b32 v109, v143, v139, s67
  v_pk_add_u16 v109, v109, v29
  v_and_or_b32 v109, v109, s65, v25
  v_mfma_f32_16x16x32_bf16 v[188:191], v[64:67], a[248:251], 0
  v_perm_b32 v110, v151, v147, s67
  v_pk_add_u16 v110, v110, v30
  v_and_or_b32 v110, v110, s65, v26
  v_perm_b32 v111, v159, v155, s67
  v_mfma_f32_16x16x32_bf16 v[188:191], v[68:71], a[252:255], v[188:191]
  v_pk_add_u16 v111, v111, v31
  v_and_or_b32 v111, v111, s65, v27
  s_add_u32 s63, s64, 99072
  buffer_store_dwordx4 v[108:111], v36, s[32:35], s63 offen sc1
  s_cmp_lg_u32 s74, 31
  s_cbranch_scc1 L_go
  buffer_store_dword v3, v54, s[32:35], s73 offen sc1
  s_add_u32 s73, s73, 1064960
  buffer_store_dword v3, v54, s[32:35], s73 offen sc1
L_go:
  v_perm_b32 v112, v164, v160, s67
  v_pk_add_u16 v112, v112, v28
  v_and_or_b32 v112, v112, s65, v24
  v_perm_b32 v113, v172, v168, s67
  v_pk_add_u16 v113, v113, v29
  v_and_or_b32 v113, v113, s65, v25
  v_perm_b32 v114, v180, v176, s67
  v_pk_add_u16 v114, v114, v30
  v_and_or_b32 v114, v114, s65, v26
  v_perm_b32 v115, v188, v184, s67
  v_pk_add_u16 v115, v115, v31
  v_and_or_b32 v115, v115, s65, v27
  s_add_u32 s63, s64, 528384
  buffer_store_dwordx4 v[112:115], v36, s[32:35], s63 offen sc1
  v_perm_b32 v116, v165, v161, s67
  v_pk_add_u16 v116, v116, v28
  v_and_or_b32 v116, v116, s65, v24
  v_perm_b32 v117, v173, v169, s67
  v_pk_add_u16 v117, v117, v29
  v_and_or_b32 v117, v117, s65, v25
  v_perm_b32 v118, v181, v177, s67
  v_pk_add_u16 v118, v118, v30
  v_and_or_b32 v118, v118, s65, v26
  v_perm_b32 v119, v189, v185, s67
  v_pk_add_u16 v119, v119, v31
  v_and_or_b32 v119, v119, s65, v27
  s_add_u32 s63, s64, 561408
  buffer_store_dwordx4 v[116:119], v36, s[32:35], s63 offen sc1
  v_perm_b32 v120, v166, v162, s67
  v_pk_add_u16 v120, v120, v28
  v_and_or_b32 v120, v120, s65, v24
  v_perm_b32 v121, v174, v170, s67
  v_pk_add_u16 v121, v121, v29
  v_and_or_b32 v121, v121, s65, v25
  v_perm_b32 v122, v182, v178, s67
  v_pk_add_u16 v122, v122, v30
  v_and_or_b32 v122, v122, s65, v26
  v_perm_b32 v123, v190, v186, s67
  v_pk_add_u16 v123, v123, v31
  v_and_or_b32 v123, v123, s65, v27
  s_add_u32 s63, s64, 594432
  buffer_store_dwordx4 v[120:123], v36, s[32:35], s63 offen sc1
  v_perm_b32 v124, v167, v163, s67
  v_pk_add_u16 v124, v124, v28
  v_and_or_b32 v124, v124, s65, v24
  v_perm_b32 v125, v175, v171, s67
  v_pk_add_u16 v125, v125, v29
  v_and_or_b32 v125, v125, s65, v25
  v_perm_b32 v126, v183, v179, s67
  v_pk_add_u16 v126, v126, v30
  v_and_or_b32 v126, v126, s65, v26
  v_perm_b32 v127, v191, v187, s67
  v_pk_add_u16 v127, v127, v31
  v_and_or_b32 v127, v127, s65, v27
  s_add_u32 s63, s64, 627456
  buffer_store_dwordx4 v[124:127], v36, s[32:35], s63 offen sc1
  s_mov_b32 s76, 0
  s_cmp_ge_u32 s31, 112
  s_cbranch_scc1 L_af1
  s_mov_b32 s40, s22
  s_mov_b32 s41, s23
  s_mov_b32 s42, 1605632
  s_mov_b32 s43, 0x20000
  s_mul_i32 s55, s31, 14336
  s_lshr_b32 s62, s3, 1
  s_mul_i32 s63, s62, 7168
  s_and_b32 s62, s3, 1
  s_mul_i32 s62, s62, 3072
  s_add_u32 s62, s62, s63
  s_add_u32 s55, s55, s62
  s_add_u32 s69, s62, 69632
  v_lshlrev_b32 v40, 4, v0
  s_add_u32 m0, s69, 0
  s_nop 0
  buffer_load_dwordx4 v40, s[40:43], s55 offen nt lds
  s_add_u32 s55, s55, 1024
  s_add_u32 m0, s69, 1024
  s_nop 0
  buffer_load_dwordx4 v40, s[40:43], s55 offen nt lds
  s_add_u32 s55, s55, 1024
  s_add_u32 m0, s69, 2048
  s_nop 0
  buffer_load_dwordx4 v40, s[40:43], s55 offen nt lds
  s_add_u32 s55, s55, 1024
  s_add_u32 m0, s69, 3072
  s_nop 0
  buffer_load_dwordx4 v40, s[40:43], s55 offen nt lds
  s_mov_b32 s76, 1
L_af1:
  v_lshrrev_b32 v43, 2, v1
  v_lshlrev_b32 v42, 1, v43
  v_add_u32 v42, v42, v12
  v_mul_u32_u24 v42, 73984, v42
  v_and_b32 v44, 1, v2
  v_lshl_add_u32 v42, v44, 6, v42
  v_and_b32 v44, 3, v0
  v_lshl_add_u32 v42, v44, 4, v42
  s_lshl_b32 s66, s3, 2
  s_cmp_eq_u32 s3, 3
  s_cselect_b32 s66, 11, s66
  s_mul_i32 s64, s66, 147968
  s_lshl_b32 s62, s31, 7
  s_add_u32 s64, s64, s62
  s_cmp_ge_u32 s3, 2
  s_cselect_b32 s67, 0x0fff0fff, -1
  v_lshl_add_u32 v46, v2, 2, v43
  v_mul_u32_u24 v46, 896, v46
  v_lshl_add_u32 v46, v44, 3, v46
  s_lshl_b32 s62, s66, 6
  v_add_u32 v46, s62, v46
  v_add_u32 v46, 69632, v46
  v_lshlrev_b32 v191, 8, v43
  v_lshl_add_u32 v191, v2, 6, v191
  v_lshl_add_u32 v191, v44, 4, v191
  s_mul_i32 s77, s31, 16640
  s_add_u32 s77, s77, 2099200
  v_mov_b32 v190, v42
  s_add_u32 s78, s64, 5259264
  s_mov_b32 s79, s67
  s_waitcnt vmcnt(0)
  buffer_load_dwordx4 v[68:71], v191, s[32:35], s77 offen sc1
  s_mov_b32 s36, s14
  s_mov_b32 s37, s15
  s_mov_b32 s38, 3670016
  s_mov_b32 s39, 0x20000
  s_mul_i32 s56, s31, 28672
  s_mul_i32 s57, s3, 7168
  s_add_u32 s56, s56, s57
  s_add_u32 s57, s57, 102400
  s_add_u32 m0, s57, 0
  s_nop 0
  buffer_load_dwordx4 v40, s[36:39], s56 offen nt lds
  s_add_u32 s56, s56, 1024
  s_add_u32 m0, s57, 1024
  s_nop 0
  buffer_load_dwordx4 v40, s[36:39], s56 offen nt lds
  s_add_u32 s56, s56, 1024
  s_add_u32 m0, s57, 2048
  s_nop 0
  buffer_load_dwordx4 v40, s[36:39], s56 offen nt lds
  s_add_u32 s56, s56, 1024
  s_add_u32 m0, s57, 3072
  s_nop 0
  buffer_load_dwordx4 v40, s[36:39], s56 offen nt lds
  s_add_u32 s56, s56, 1024
  s_add_u32 m0, s57, 4096
  s_nop 0
  buffer_load_dwordx4 v40, s[36:39], s56 offen nt lds
  s_add_u32 s56, s56, 1024
  s_add_u32 m0, s57, 5120
  s_nop 0
  buffer_load_dwordx4 v40, s[36:39], s56 offen nt lds
  s_add_u32 s56, s56, 1024
  s_add_u32 m0, s57, 6144
  s_nop 0
  buffer_load_dwordx4 v40, s[36:39], s56 offen nt lds
  s_barrier
  ds_read_b64_tr_b16 v[192:193], v46 offset:0
  ds_read_b64_tr_b16 v[194:195], v46 offset:32
  ds_read_b64_tr_b16 v[196:197], v46 offset:64
  ds_read_b64_tr_b16 v[198:199], v46 offset:96
  ds_read_b64_tr_b16 v[200:201], v46 offset:128
  ds_read_b64_tr_b16 v[202:203], v46 offset:160
  ds_read_b64_tr_b16 v[204:205], v46 offset:192
  ds_read_b64_tr_b16 v[206:207], v46 offset:224
  v_add_u32 v46, 32768, v46
  s_cmp_eq_u32 s76, 0
  s_cbranch_scc1 L_af2
  s_waitcnt vmcnt(7)
  v_perm_b32 v53, v69, v68, s48
  v_perm_b32 v54, v71, v70, s49
  v_or_b32 v53, v53, v54
  v_xor_b32 v55, v53, v3
  v_cmp_ne_u32 vcc, 0, v55
  s_cbranch_vccnz L_af2
  v_add_f32_dpp v68, v68, v68 row_ror:4 row_mask:0xf bank_mask:0xf
  v_add_f32_dpp v69, v69, v69 row_ror:4 row_mask:0xf bank_mask:0xf
  v_add_f32_dpp v70, v70, v70 row_ror:4 row_mask:0xf bank_mask:0xf
  v_add_f32_dpp v71, v71, v71 row_ror:4 row_mask:0xf bank_mask:0xf
  v_add_f32_dpp v68, v68, v68 row_ror:8 row_mask:0xf bank_mask:0xf
  v_add_f32_dpp v69, v69, v69 row_ror:8 row_mask:0xf bank_mask:0xf
  v_add_f32_dpp v70, v70, v70 row_ror:8 row_mask:0xf bank_mask:0xf
  v_add_f32_dpp v71, v71, v71 row_ror:8 row_mask:0xf bank_mask:0xf
  v_cvt_pk_bf16_f32 v68, v68, v68
  v_and_b32 v68, 0xffff0000, v68
  v_cvt_pk_bf16_f32 v69, v69, v69
  v_and_b32 v69, 0xffff0000, v69
  v_cvt_pk_bf16_f32 v70, v70, v70
  v_and_b32 v70, 0xffff0000, v70
  v_cvt_pk_bf16_f32 v71, v71, v71
  v_and_b32 v71, 0xffff0000, v71
  v_mov_b32_dpp v72, v68 quad_perm:[0,1,0,1] row_mask:0xf bank_mask:0xf
  v_mov_b32_dpp v76, v68 quad_perm:[2,3,2,3] row_mask:0xf bank_mask:0xf
  v_mov_b32_dpp v73, v69 quad_perm:[0,1,0,1] row_mask:0xf bank_mask:0xf
  v_mov_b32_dpp v77, v69 quad_perm:[2,3,2,3] row_mask:0xf bank_mask:0xf
  v_mov_b32_dpp v74, v70 quad_perm:[0,1,0,1] row_mask:0xf bank_mask:0xf
  v_mov_b32_dpp v78, v70 quad_perm:[2,3,2,3] row_mask:0xf bank_mask:0xf
  v_mov_b32_dpp v75, v71 quad_perm:[0,1,0,1] row_mask:0xf bank_mask:0xf
  v_mov_b32_dpp v79, v71 quad_perm:[2,3,2,3] row_mask:0xf bank_mask:0xf
  s_mov_b32 s62, 0xbdd2d3e8
  v_mov_b32 v84, 0xc0135761
  v_mul_f32 v80, v72, v72
  v_fma_f32 v80, v80, s62, v84
  v_mul_f32 v80, v80, v72
  v_mul_f32 v81, v73, v73
  v_fma_f32 v81, v81, s62, v84
  v_mul_f32 v81, v81, v73
  v_mul_f32 v82, v74, v74
  v_fma_f32 v82, v82, s62, v84
  v_mul_f32 v82, v82, v74
  v_mul_f32 v83, v75, v75
  v_fma_f32 v83, v83, s62, v84
  v_mul_f32 v83, v83, v75
  v_exp_f32 v80, v80
  v_exp_f32 v81, v81
  v_exp_f32 v82, v82
  v_exp_f32 v83, v83
  v_add_f32 v80, 1.0, v80
  v_add_f32 v81, 1.0, v81
  v_add_f32 v82, 1.0, v82
  v_add_f32 v83, 1.0, v83
  v_rcp_f32 v80, v80
  v_rcp_f32 v81, v81
  v_rcp_f32 v82, v82
  v_rcp_f32 v83, v83
  v_mul_f32 v80, v80, v72
  v_mul_f32 v81, v81, v73
  v_mul_f32 v82, v82, v74
  v_mul_f32 v83, v83, v75
  v_cvt_pk_bf16_f32 v80, v80, v80
  v_and_b32 v80, 0xffff0000, v80
  v_cvt_pk_bf16_f32 v81, v81, v81
  v_and_b32 v81, 0xffff0000, v81
  v_cvt_pk_bf16_f32 v82, v82, v82
  v_and_b32 v82, 0xffff0000, v82
  v_cvt_pk_bf16_f32 v83, v83, v83
  v_and_b32 v83, 0xffff0000, v83
  v_mul_f32 v80, v80, v76
  v_mul_f32 v81, v81, v77
  v_mul_f32 v82, v82, v78
  v_mul_f32 v83, v83, v79
  v_cvt_pk_bf16_f32 v80, v80, v81
  v_cvt_pk_bf16_f32 v81, v82, v83
  s_waitcnt lgkmcnt(0)
  s_nop 0
  v_mfma_f32_16x16x16_bf16 v[128:131], v[192:193], v[80:81], 0
  v_mfma_f32_16x16x16_bf16 v[132:135], v[194:195], v[80:81], 0
  v_mfma_f32_16x16x16_bf16 v[136:139], v[196:197], v[80:81], 0
  v_mfma_f32_16x16x16_bf16 v[140:143], v[198:199], v[80:81], 0
  v_mfma_f32_16x16x16_bf16 v[144:147], v[200:201], v[80:81], 0
  v_mfma_f32_16x16x16_bf16 v[148:151], v[202:203], v[80:81], 0
  v_mfma_f32_16x16x16_bf16 v[152:155], v[204:205], v[80:81], 0
  v_mfma_f32_16x16x16_bf16 v[156:159], v[206:207], v[80:81], 0
  s_mov_b32 exec_lo, 0x30003
  s_mov_b32 exec_hi, 0x30003
  v_perm_b32 v64, v128, v3, s44
  v_perm_b32 v65, v129, v3, s45
  v_perm_b32 v66, v130, v3, s46
  v_perm_b32 v67, v131, v3, s47
  s_mov_b32 exec_lo, 0xc000c
  s_mov_b32 exec_hi, 0xc000c
  v_perm_b32 v64, v132, v3, s44
  v_perm_b32 v65, v133, v3, s45
  v_perm_b32 v66, v134, v3, s46
  v_perm_b32 v67, v135, v3, s47
  s_mov_b32 exec_lo, 0x300030
  s_mov_b32 exec_hi, 0x300030
  v_perm_b32 v64, v136, v3, s44
  v_perm_b32 v65, v137, v3, s45
  v_perm_b32 v66, v138, v3, s46
  v_perm_b32 v67, v139, v3, s47
  s_mov_b32 exec_lo, 0xc000c0
  s_mov_b32 exec_hi, 0xc000c0
  v_perm_b32 v64, v140, v3, s44
  v_perm_b32 v65, v141, v3, s45
  v_perm_b32 v66, v142, v3, s46
  v_perm_b32 v67, v143, v3, s47
  s_mov_b32 exec_lo, 0x3000300
  s_mov_b32 exec_hi, 0x3000300
  v_perm_b32 v64, v144, v3, s44
  v_perm_b32 v65, v145, v3, s45
  v_perm_b32 v66, v146, v3, s46
  v_perm_b32 v67, v147, v3, s47
  s_mov_b32 exec_lo, 0xc000c00
  s_mov_b32 exec_hi, 0xc000c00
  v_perm_b32 v64, v148, v3, s44
  v_perm_b32 v65, v149, v3, s45
  v_perm_b32 v66, v150, v3, s46
  v_perm_b32 v67, v151, v3, s47
  s_mov_b32 exec_lo, 0x30003000
  s_mov_b32 exec_hi, 0x30003000
  v_perm_b32 v64, v152, v3, s44
  v_perm_b32 v65, v153, v3, s45
  v_perm_b32 v66, v154, v3, s46
  v_perm_b32 v67, v155, v3, s47
  s_mov_b32 exec_lo, 0xc000c000
  s_mov_b32 exec_hi, 0xc000c000
  v_perm_b32 v64, v156, v3, s44
  v_perm_b32 v65, v157, v3, s45
  v_perm_b32 v66, v158, v3, s46
  v_perm_b32 v67, v159, v3, s47
  s_mov_b32 exec_lo, s79
  s_mov_b32 exec_hi, s79
  buffer_store_dwordx4 v[64:67], v190, s[32:35], s78 offen sc1
  s_mov_b64 exec, -1
  s_mov_b32 s76, 0
  s_nop 1
  s_waitcnt vmcnt(1)
  s_branch L_af3
L_af2:
  s_waitcnt vmcnt(0)
L_af3:
  s_barrier
  s_cmp_eq_u32 s76, 0
  s_cbranch_scc1 L_af4
  buffer_load_dwordx4 v[68:71], v191, s[32:35], s77 offen sc1
  s_waitcnt vmcnt(0)
  v_perm_b32 v53, v69, v68, s48
  v_perm_b32 v54, v71, v70, s49
  v_or_b32 v53, v53, v54
  v_xor_b32 v55, v53, v3
  v_cmp_ne_u32 vcc, 0, v55
  s_cbranch_vccnz L_af4
  v_add_f32_dpp v68, v68, v68 row_ror:4 row_mask:0xf bank_mask:0xf
  v_add_f32_dpp v69, v69, v69 row_ror:4 row_mask:0xf bank_mask:0xf
  v_add_f32_dpp v70, v70, v70 row_ror:4 row_mask:0xf bank_mask:0xf
  v_add_f32_dpp v71, v71, v71 row_ror:4 row_mask:0xf bank_mask:0xf
  v_add_f32_dpp v68, v68, v68 row_ror:8 row_mask:0xf bank_mask:0xf
  v_add_f32_dpp v69, v69, v69 row_ror:8 row_mask:0xf bank_mask:0xf
  v_add_f32_dpp v70, v70, v70 row_ror:8 row_mask:0xf bank_mask:0xf
  v_add_f32_dpp v71, v71, v71 row_ror:8 row_mask:0xf bank_mask:0xf
  v_cvt_pk_bf16_f32 v68, v68, v68
  v_and_b32 v68, 0xffff0000, v68
  v_cvt_pk_bf16_f32 v69, v69, v69
  v_and_b32 v69, 0xffff0000, v69
  v_cvt_pk_bf16_f32 v70, v70, v70
  v_and_b32 v70, 0xffff0000, v70
  v_cvt_pk_bf16_f32 v71, v71, v71
  v_and_b32 v71, 0xffff0000, v71
  v_mov_b32_dpp v72, v68 quad_perm:[0,1,0,1] row_mask:0xf bank_mask:0xf
  v_mov_b32_dpp v76, v68 quad_perm:[2,3,2,3] row_mask:0xf bank_mask:0xf
  v_mov_b32_dpp v73, v69 quad_perm:[0,1,0,1] row_mask:0xf bank_mask:0xf
  v_mov_b32_dpp v77, v69 quad_perm:[2,3,2,3] row_mask:0xf bank_mask:0xf
  v_mov_b32_dpp v74, v70 quad_perm:[0,1,0,1] row_mask:0xf bank_mask:0xf
  v_mov_b32_dpp v78, v70 quad_perm:[2,3,2,3] row_mask:0xf bank_mask:0xf
  v_mov_b32_dpp v75, v71 quad_perm:[0,1,0,1] row_mask:0xf bank_mask:0xf
  v_mov_b32_dpp v79, v71 quad_perm:[2,3,2,3] row_mask:0xf bank_mask:0xf
  s_mov_b32 s62, 0xbdd2d3e8
  v_mov_b32 v84, 0xc0135761
  v_mul_f32 v80, v72, v72
  v_fma_f32 v80, v80, s62, v84
  v_mul_f32 v80, v80, v72
  v_mul_f32 v81, v73, v73
  v_fma_f32 v81, v81, s62, v84
  v_mul_f32 v81, v81, v73
  v_mul_f32 v82, v74, v74
  v_fma_f32 v82, v82, s62, v84
  v_mul_f32 v82, v82, v74
  v_mul_f32 v83, v75, v75
  v_fma_f32 v83, v83, s62, v84
  v_mul_f32 v83, v83, v75
  v_exp_f32 v80, v80
  v_exp_f32 v81, v81
  v_exp_f32 v82, v82
  v_exp_f32 v83, v83
  v_add_f32 v80, 1.0, v80
  v_add_f32 v81, 1.0, v81
  v_add_f32 v82, 1.0, v82
  v_add_f32 v83, 1.0, v83
  v_rcp_f32 v80, v80
  v_rcp_f32 v81, v81
  v_rcp_f32 v82, v82
  v_rcp_f32 v83, v83
  v_mul_f32 v80, v80, v72
  v_mul_f32 v81, v81, v73
  v_mul_f32 v82, v82, v74
  v_mul_f32 v83, v83, v75
  v_cvt_pk_bf16_f32 v80, v80, v80
  v_and_b32 v80, 0xffff0000, v80
  v_cvt_pk_bf16_f32 v81, v81, v81
  v_and_b32 v81, 0xffff0000, v81
  v_cvt_pk_bf16_f32 v82, v82, v82
  v_and_b32 v82, 0xffff0000, v82
  v_cvt_pk_bf16_f32 v83, v83, v83
  v_and_b32 v83, 0xffff0000, v83
  v_mul_f32 v80, v80, v76
  v_mul_f32 v81, v81, v77
  v_mul_f32 v82, v82, v78
  v_mul_f32 v83, v83, v79
  v_cvt_pk_bf16_f32 v80, v80, v81
  v_cvt_pk_bf16_f32 v81, v82, v83
  s_waitcnt lgkmcnt(0)
  s_nop 0
  v_mfma_f32_16x16x16_bf16 v[128:131], v[192:193], v[80:81], 0
  v_mfma_f32_16x16x16_bf16 v[132:135], v[194:195], v[80:81], 0
  v_mfma_f32_16x16x16_bf16 v[136:139], v[196:197], v[80:81], 0
  v_mfma_f32_16x16x16_bf16 v[140:143], v[198:199], v[80:81], 0
  v_mfma_f32_16x16x16_bf16 v[144:147], v[200:201], v[80:81], 0
  v_mfma_f32_16x16x16_bf16 v[148:151], v[202:203], v[80:81], 0
  v_mfma_f32_16x16x16_bf16 v[152:155], v[204:205], v[80:81], 0
  v_mfma_f32_16x16x16_bf16 v[156:159], v[206:207], v[80:81], 0
  s_mov_b32 exec_lo, 0x30003
  s_mov_b32 exec_hi, 0x30003
  v_perm_b32 v64, v128, v3, s44
  v_perm_b32 v65, v129, v3, s45
  v_perm_b32 v66, v130, v3, s46
  v_perm_b32 v67, v131, v3, s47
  s_mov_b32 exec_lo, 0xc000c
  s_mov_b32 exec_hi, 0xc000c
  v_perm_b32 v64, v132, v3, s44
  v_perm_b32 v65, v133, v3, s45
  v_perm_b32 v66, v134, v3, s46
  v_perm_b32 v67, v135, v3, s47
  s_mov_b32 exec_lo, 0x300030
  s_mov_b32 exec_hi, 0x300030
  v_perm_b32 v64, v136, v3, s44
  v_perm_b32 v65, v137, v3, s45
  v_perm_b32 v66, v138, v3, s46
  v_perm_b32 v67, v139, v3, s47
  s_mov_b32 exec_lo, 0xc000c0
  s_mov_b32 exec_hi, 0xc000c0
  v_perm_b32 v64, v140, v3, s44
  v_perm_b32 v65, v141, v3, s45
  v_perm_b32 v66, v142, v3, s46
  v_perm_b32 v67, v143, v3, s47
  s_mov_b32 exec_lo, 0x3000300
  s_mov_b32 exec_hi, 0x3000300
  v_perm_b32 v64, v144, v3, s44
  v_perm_b32 v65, v145, v3, s45
  v_perm_b32 v66, v146, v3, s46
  v_perm_b32 v67, v147, v3, s47
  s_mov_b32 exec_lo, 0xc000c00
  s_mov_b32 exec_hi, 0xc000c00
  v_perm_b32 v64, v148, v3, s44
  v_perm_b32 v65, v149, v3, s45
  v_perm_b32 v66, v150, v3, s46
  v_perm_b32 v67, v151, v3, s47
  s_mov_b32 exec_lo, 0x30003000
  s_mov_b32 exec_hi, 0x30003000
  v_perm_b32 v64, v152, v3, s44
  v_perm_b32 v65, v153, v3, s45
  v_perm_b32 v66, v154, v3, s46
  v_perm_b32 v67, v155, v3, s47
  s_mov_b32 exec_lo, 0xc000c000
  s_mov_b32 exec_hi, 0xc000c000
  v_perm_b32 v64, v156, v3, s44
  v_perm_b32 v65, v157, v3, s45
  v_perm_b32 v66, v158, v3, s46
  v_perm_b32 v67, v159, v3, s47
  s_mov_b32 exec_lo, s79
  s_mov_b32 exec_hi, s79
  buffer_store_dwordx4 v[64:67], v190, s[32:35], s78 offen sc1
  s_mov_b64 exec, -1
  s_mov_b32 s76, 0
  s_nop 1
L_af4:
  ds_read_b64_tr_b16 v[96:97], v46 offset:0
  ds_read_b64_tr_b16 v[98:99], v46 offset:14336
  ds_read_b64_tr_b16 v[100:101], v46 offset:32
  ds_read_b64_tr_b16 v[102:103], v46 offset:14368
  ds_read_b64_tr_b16 v[104:105], v46 offset:64
  ds_read_b64_tr_b16 v[106:107], v46 offset:14400
  ds_read_b64_tr_b16 v[108:109], v46 offset:96
  ds_read_b64_tr_b16 v[110:111], v46 offset:14432
  ds_read_b64_tr_b16 v[112:113], v46 offset:128
  ds_read_b64_tr_b16 v[114:115], v46 offset:14464
  ds_read_b64_tr_b16 v[116:117], v46 offset:160
  ds_read_b64_tr_b16 v[118:119], v46 offset:14496
  ds_read_b64_tr_b16 v[120:121], v46 offset:192
  ds_read_b64_tr_b16 v[122:123], v46 offset:14528
  ds_read_b64_tr_b16 v[124:125], v46 offset:224
  ds_read_b64_tr_b16 v[126:127], v46 offset:14560
  v_lshrrev_b32 v45, 1, v1
  v_lshlrev_b32 v45, 8, v45
  v_lshl_add_u32 v45, v2, 6, v45
  v_lshl_add_u32 v45, v14, 4, v45
  s_mul_i32 s63, s31, 16640
  s_add_u32 s63, s63, 2097152
  s_mov_b32 s96, 400000
  buffer_load_dwordx4 v[164:167], v45, s[32:35], s63 offen offset:0 sc1
  buffer_load_dwordx4 v[168:171], v45, s[32:35], s63 offen offset:32 sc1
  s_sleep 1
L_ac:
  buffer_load_dwordx4 v[172:175], v45, s[32:35], s63 offen offset:0 sc1
  buffer_load_dwordx4 v[176:179], v45, s[32:35], s63 offen offset:32 sc1
  s_waitcnt vmcnt(2)
  v_perm_b32 v53, v165, v164, s48
  v_perm_b32 v54, v167, v166, s49
  v_or_b32 v53, v53, v54
  v_xor_b32 v55, v53, v3
  v_perm_b32 v53, v169, v168, s48
  v_perm_b32 v54, v171, v170, s49
  v_or_b32 v53, v53, v54
  v_xor_b32 v53, v53, v3
  v_or_b32 v55, v55, v53
  v_cmp_ne_u32 vcc, 0, v55
  s_cbranch_vccz L_ac_x
  buffer_load_dwordx4 v[164:167], v45, s[32:35], s63 offen offset:0 sc1
  buffer_load_dwordx4 v[168:171], v45, s[32:35], s63 offen offset:32 sc1
  s_sub_u32 s96, s96, 1
  s_cbranch_scc1 L_end
  s_waitcnt vmcnt(2)
  v_perm_b32 v53, v173, v172, s48
  v_perm_b32 v54, v175, v174, s49
  v_or_b32 v53, v53, v54
  v_xor_b32 v55, v53, v3
  v_perm_b32 v53, v177, v176, s48
  v_perm_b32 v54, v179, v178, s49
  v_or_b32 v53, v53, v54
  v_xor_b32 v53, v53, v3
  v_or_b32 v55, v55, v53
  v_cmp_ne_u32 vcc, 0, v55
  s_cbranch_vccnz L_ac
  v_add_f32_dpp v68, v172, v172 row_ror:2 row_mask:0xf bank_mask:0xf
  v_add_f32_dpp v69, v173, v173 row_ror:2 row_mask:0xf bank_mask:0xf
  v_add_f32_dpp v70, v174, v174 row_ror:2 row_mask:0xf bank_mask:0xf
  v_add_f32_dpp v71, v175, v175 row_ror:2 row_mask:0xf bank_mask:0xf
  v_add_f32_dpp v72, v176, v176 row_ror:2 row_mask:0xf bank_mask:0xf
  v_add_f32_dpp v73, v177, v177 row_ror:2 row_mask:0xf bank_mask:0xf
  v_add_f32_dpp v74, v178, v178 row_ror:2 row_mask:0xf bank_mask:0xf
  v_add_f32_dpp v75, v179, v179 row_ror:2 row_mask:0xf bank_mask:0xf
  s_branch L_ac_j
L_ac_x:
  v_add_f32_dpp v68, v164, v164 row_ror:2 row_mask:0xf bank_mask:0xf
  v_add_f32_dpp v69, v165, v165 row_ror:2 row_mask:0xf bank_mask:0xf
  v_add_f32_dpp v70, v166, v166 row_ror:2 row_mask:0xf bank_mask:0xf
  v_add_f32_dpp v71, v167, v167 row_ror:2 row_mask:0xf bank_mask:0xf
  v_add_f32_dpp v72, v168, v168 row_ror:2 row_mask:0xf bank_mask:0xf
  v_add_f32_dpp v73, v169, v169 row_ror:2 row_mask:0xf bank_mask:0xf
  v_add_f32_dpp v74, v170, v170 row_ror:2 row_mask:0xf bank_mask:0xf
  v_add_f32_dpp v75, v171, v171 row_ror:2 row_mask:0xf bank_mask:0xf
L_ac_j:
  v_add_f32_dpp v68, v68, v68 row_ror:4 row_mask:0xf bank_mask:0xf
  v_add_f32_dpp v69, v69, v69 row_ror:4 row_mask:0xf bank_mask:0xf
  v_add_f32_dpp v70, v70, v70 row_ror:4 row_mask:0xf bank_mask:0xf
  v_add_f32_dpp v71, v71, v71 row_ror:4 row_mask:0xf bank_mask:0xf
  v_add_f32_dpp v72, v72, v72 row_ror:4 row_mask:0xf bank_mask:0xf
  v_add_f32_dpp v73, v73, v73 row_ror:4 row_mask:0xf bank_mask:0xf
  v_add_f32_dpp v74, v74, v74 row_ror:4 row_mask:0xf bank_mask:0xf
  v_add_f32_dpp v75, v75, v75 row_ror:4 row_mask:0xf bank_mask:0xf
  v_add_f32_dpp v68, v68, v68 row_ror:8 row_mask:0xf bank_mask:0xf
  v_add_f32_dpp v69, v69, v69 row_ror:8 row_mask:0xf bank_mask:0xf
  v_add_f32_dpp v70, v70, v70 row_ror:8 row_mask:0xf bank_mask:0xf
  v_add_f32_dpp v71, v71, v71 row_ror:8 row_mask:0xf bank_mask:0xf
  v_add_f32_dpp v72, v72, v72 row_ror:8 row_mask:0xf bank_mask:0xf
  v_add_f32_dpp v73, v73, v73 row_ror:8 row_mask:0xf bank_mask:0xf
  v_add_f32_dpp v74, v74, v74 row_ror:8 row_mask:0xf bank_mask:0xf
  v_add_f32_dpp v75, v75, v75 row_ror:8 row_mask:0xf bank_mask:0xf
  v_cvt_pk_bf16_f32 v80, v68, v69
  v_cvt_pk_bf16_f32 v81, v70, v71
  v_cvt_pk_bf16_f32 v82, v72, v73
  v_cvt_pk_bf16_f32 v83, v74, v75
  s_waitcnt lgkmcnt(0)
  s_nop 0
  v_mfma_f32_16x16x32_bf16 v[128:131], v[96:99], v[80:83], 0
  v_mfma_f32_16x16x32_bf16 v[132:135], v[100:103], v[80:83], 0
  v_mfma_f32_16x16x32_bf16 v[136:139], v[104:107], v[80:83], 0
  v_mfma_f32_16x16x32_bf16 v[140:143], v[108:111], v[80:83], 0
  v_mfma_f32_16x16x32_bf16 v[144:147], v[112:115], v[80:83], 0
  v_mfma_f32_16x16x32_bf16 v[148:151], v[116:119], v[80:83], 0
  v_mfma_f32_16x16x32_bf16 v[152:155], v[120:123], v[80:83], 0
  v_mfma_f32_16x16x32_bf16 v[156:159], v[124:127], v[80:83], 0
  s_mov_b32 exec_lo, 0x30003
  s_mov_b32 exec_hi, 0x30003
  v_perm_b32 v64, v128, v3, s44
  v_perm_b32 v65, v129, v3, s45
  v_perm_b32 v66, v130, v3, s46
  v_perm_b32 v67, v131, v3, s47
  s_mov_b32 exec_lo, 0xc000c
  s_mov_b32 exec_hi, 0xc000c
  v_perm_b32 v64, v132, v3, s44
  v_perm_b32 v65, v133, v3, s45
  v_perm_b32 v66, v134, v3, s46
  v_perm_b32 v67, v135, v3, s47
  s_mov_b32 exec_lo, 0x300030
  s_mov_b32 exec_hi, 0x300030
  v_perm_b32 v64, v136, v3, s44
  v_perm_b32 v65, v137, v3, s45
  v_perm_b32 v66, v138, v3, s46
  v_perm_b32 v67, v139, v3, s47
  s_mov_b32 exec_lo, 0xc000c0
  s_mov_b32 exec_hi, 0xc000c0
  v_perm_b32 v64, v140, v3, s44
  v_perm_b32 v65, v141, v3, s45
  v_perm_b32 v66, v142, v3, s46
  v_perm_b32 v67, v143, v3, s47
  s_mov_b32 exec_lo, 0x3000300
  s_mov_b32 exec_hi, 0x3000300
  v_perm_b32 v64, v144, v3, s44
  v_perm_b32 v65, v145, v3, s45
  v_perm_b32 v66, v146, v3, s46
  v_perm_b32 v67, v147, v3, s47
  s_mov_b32 exec_lo, 0xc000c00
  s_mov_b32 exec_hi, 0xc000c00
  v_perm_b32 v64, v148, v3, s44
  v_perm_b32 v65, v149, v3, s45
  v_perm_b32 v66, v150, v3, s46
  v_perm_b32 v67, v151, v3, s47
  s_mov_b32 exec_lo, 0x30003000
  s_mov_b32 exec_hi, 0x30003000
  v_perm_b32 v64, v152, v3, s44
  v_perm_b32 v65, v153, v3, s45
  v_perm_b32 v66, v154, v3, s46
  v_perm_b32 v67, v155, v3, s47
  s_mov_b32 exec_lo, 0xc000c000
  s_mov_b32 exec_hi, 0xc000c000
  v_perm_b32 v64, v156, v3, s44
  v_perm_b32 v65, v157, v3, s45
  v_perm_b32 v66, v158, v3, s46
  v_perm_b32 v67, v159, v3, s47
  s_mov_b32 exec_lo, s67
  s_mov_b32 exec_hi, s67
  s_add_u32 s62, s64, 5242880
  buffer_store_dwordx4 v[64:67], v42, s[32:35], s62 offen sc1
  s_mov_b64 exec, -1
  s_cmp_eq_u32 s76, 0
  s_cbranch_scc1 L_end
  s_mov_b32 s96, 400000
L_f2c:
  s_sub_u32 s96, s96, 1
  s_cbranch_scc1 L_end
  buffer_load_dwordx4 v[68:71], v191, s[32:35], s77 offen sc1
  s_waitcnt vmcnt(0)
  v_perm_b32 v53, v69, v68, s48
  v_perm_b32 v54, v71, v70, s49
  v_or_b32 v53, v53, v54
  v_xor_b32 v55, v53, v3
  v_cmp_ne_u32 vcc, 0, v55
  s_cbranch_vccnz L_f2c
  v_add_f32_dpp v68, v68, v68 row_ror:4 row_mask:0xf bank_mask:0xf
  v_add_f32_dpp v69, v69, v69 row_ror:4 row_mask:0xf bank_mask:0xf
  v_add_f32_dpp v70, v70, v70 row_ror:4 row_mask:0xf bank_mask:0xf
  v_add_f32_dpp v71, v71, v71 row_ror:4 row_mask:0xf bank_mask:0xf
  v_add_f32_dpp v68, v68, v68 row_ror:8 row_mask:0xf bank_mask:0xf
  v_add_f32_dpp v69, v69, v69 row_ror:8 row_mask:0xf bank_mask:0xf
  v_add_f32_dpp v70, v70, v70 row_ror:8 row_mask:0xf bank_mask:0xf
  v_add_f32_dpp v71, v71, v71 row_ror:8 row_mask:0xf bank_mask:0xf
  v_cvt_pk_bf16_f32 v68, v68, v68
  v_and_b32 v68, 0xffff0000, v68
  v_cvt_pk_bf16_f32 v69, v69, v69
  v_and_b32 v69, 0xffff0000, v69
  v_cvt_pk_bf16_f32 v70, v70, v70
  v_and_b32 v70, 0xffff0000, v70
  v_cvt_pk_bf16_f32 v71, v71, v71
  v_and_b32 v71, 0xffff0000, v71
  v_mov_b32_dpp v72, v68 quad_perm:[0,1,0,1] row_mask:0xf bank_mask:0xf
  v_mov_b32_dpp v76, v68 quad_perm:[2,3,2,3] row_mask:0xf bank_mask:0xf
  v_mov_b32_dpp v73, v69 quad_perm:[0,1,0,1] row_mask:0xf bank_mask:0xf
  v_mov_b32_dpp v77, v69 quad_perm:[2,3,2,3] row_mask:0xf bank_mask:0xf
  v_mov_b32_dpp v74, v70 quad_perm:[0,1,0,1] row_mask:0xf bank_mask:0xf
  v_mov_b32_dpp v78, v70 quad_perm:[2,3,2,3] row_mask:0xf bank_mask:0xf
  v_mov_b32_dpp v75, v71 quad_perm:[0,1,0,1] row_mask:0xf bank_mask:0xf
  v_mov_b32_dpp v79, v71 quad_perm:[2,3,2,3] row_mask:0xf bank_mask:0xf
  s_mov_b32 s62, 0xbdd2d3e8
  v_mov_b32 v84, 0xc0135761
  v_mul_f32 v80, v72, v72
  v_fma_f32 v80, v80, s62, v84
  v_mul_f32 v80, v80, v72
  v_mul_f32 v81, v73, v73
  v_fma_f32 v81, v81, s62, v84
  v_mul_f32 v81, v81, v73
  v_mul_f32 v82, v74, v74
  v_fma_f32 v82, v82, s62, v84
  v_mul_f32 v82, v82, v74
  v_mul_f32 v83, v75, v75
  v_fma_f32 v83, v83, s62, v84
  v_mul_f32 v83, v83, v75
  v_exp_f32 v80, v80
  v_exp_f32 v81, v81
  v_exp_f32 v82, v82
  v_exp_f32 v83, v83
  v_add_f32 v80, 1.0, v80
  v_add_f32 v81, 1.0, v81
  v_add_f32 v82, 1.0, v82
  v_add_f32 v83, 1.0, v83
  v_rcp_f32 v80, v80
  v_rcp_f32 v81, v81
  v_rcp_f32 v82, v82
  v_rcp_f32 v83, v83
  v_mul_f32 v80, v80, v72
  v_mul_f32 v81, v81, v73
  v_mul_f32 v82, v82, v74
  v_mul_f32 v83, v83, v75
  v_cvt_pk_bf16_f32 v80, v80, v80
  v_and_b32 v80, 0xffff0000, v80
  v_cvt_pk_bf16_f32 v81, v81, v81
  v_and_b32 v81, 0xffff0000, v81
  v_cvt_pk_bf16_f32 v82, v82, v82
  v_and_b32 v82, 0xffff0000, v82
  v_cvt_pk_bf16_f32 v83, v83, v83
  v_and_b32 v83, 0xffff0000, v83
  v_mul_f32 v80, v80, v76
  v_mul_f32 v81, v81, v77
  v_mul_f32 v82, v82, v78
  v_mul_f32 v83, v83, v79
  v_cvt_pk_bf16_f32 v80, v80, v81
  v_cvt_pk_bf16_f32 v81, v82, v83
  s_waitcnt lgkmcnt(0)
  s_nop 0
  v_mfma_f32_16x16x16_bf16 v[128:131], v[192:193], v[80:81], 0
  v_mfma_f32_16x16x16_bf16 v[132:135], v[194:195], v[80:81], 0
  v_mfma_f32_16x16x16_bf16 v[136:139], v[196:197], v[80:81], 0
  v_mfma_f32_16x16x16_bf16 v[140:143], v[198:199], v[80:81], 0
  v_mfma_f32_16x16x16_bf16 v[144:147], v[200:201], v[80:81], 0
  v_mfma_f32_16x16x16_bf16 v[148:151], v[202:203], v[80:81], 0
  v_mfma_f32_16x16x16_bf16 v[152:155], v[204:205], v[80:81], 0
  v_mfma_f32_16x16x16_bf16 v[156:159], v[206:207], v[80:81], 0
  s_mov_b32 exec_lo, 0x30003
  s_mov_b32 exec_hi, 0x30003
  v_perm_b32 v64, v128, v3, s44
  v_perm_b32 v65, v129, v3, s45
  v_perm_b32 v66, v130, v3, s46
  v_perm_b32 v67, v131, v3, s47
  s_mov_b32 exec_lo, 0xc000c
  s_mov_b32 exec_hi, 0xc000c
  v_perm_b32 v64, v132, v3, s44
  v_perm_b32 v65, v133, v3, s45
  v_perm_b32 v66, v134, v3, s46
  v_perm_b32 v67, v135, v3, s47
  s_mov_b32 exec_lo, 0x300030
  s_mov_b32 exec_hi, 0x300030
  v_perm_b32 v64, v136, v3, s44
  v_perm_b32 v65, v137, v3, s45
  v_perm_b32 v66, v138, v3, s46
  v_perm_b32 v67, v139, v3, s47
  s_mov_b32 exec_lo, 0xc000c0
  s_mov_b32 exec_hi, 0xc000c0
  v_perm_b32 v64, v140, v3, s44
  v_perm_b32 v65, v141, v3, s45
  v_perm_b32 v66, v142, v3, s46
  v_perm_b32 v67, v143, v3, s47
  s_mov_b32 exec_lo, 0x3000300
  s_mov_b32 exec_hi, 0x3000300
  v_perm_b32 v64, v144, v3, s44
  v_perm_b32 v65, v145, v3, s45
  v_perm_b32 v66, v146, v3, s46
  v_perm_b32 v67, v147, v3, s47
  s_mov_b32 exec_lo, 0xc000c00
  s_mov_b32 exec_hi, 0xc000c00
  v_perm_b32 v64, v148, v3, s44
  v_perm_b32 v65, v149, v3, s45
  v_perm_b32 v66, v150, v3, s46
  v_perm_b32 v67, v151, v3, s47
  s_mov_b32 exec_lo, 0x30003000
  s_mov_b32 exec_hi, 0x30003000
  v_perm_b32 v64, v152, v3, s44
  v_perm_b32 v65, v153, v3, s45
  v_perm_b32 v66, v154, v3, s46
  v_perm_b32 v67, v155, v3, s47
  s_mov_b32 exec_lo, 0xc000c000
  s_mov_b32 exec_hi, 0xc000c000
  v_perm_b32 v64, v156, v3, s44
  v_perm_b32 v65, v157, v3, s45
  v_perm_b32 v66, v158, v3, s46
  v_perm_b32 v67, v159, v3, s47
  s_mov_b32 exec_lo, s79
  s_mov_b32 exec_hi, s79
  buffer_store_dwordx4 v[64:67], v190, s[32:35], s78 offen sc1
  s_mov_b64 exec, -1
  s_mov_b32 s76, 0
  s_nop 1
L_end:
L_end0:
  s_endpgm
.fill (22*1024 - (. - recurrent_scan__compressed_kv_cla__geglu_ffn__decode_kernel))/4, 4, 0xbf800000
.section .rodata,"a"
.p2align 6
.amdhsa_kernel recurrent_scan__compressed_kv_cla__geglu_ffn__decode_kernel
  .amdhsa_next_free_vgpr 512
  .amdhsa_next_free_sgpr 102
  .amdhsa_accum_offset 256
  .amdhsa_group_segment_fixed_size 0
  .amdhsa_kernarg_size 104
  .amdhsa_user_sgpr_count 2
  .amdhsa_user_sgpr_kernarg_segment_ptr 1
  .amdhsa_system_sgpr_workgroup_id_x 1
.end_amdhsa_kernel
```
